```python
import torch

def _softmax(x, axis=-1):
    return torch.softmax(x, dim=axis)
def _gelu(x):
    return torch.nn.functional.gelu(x, approximate="tanh")
def _silu(x):
    return torch.nn.functional.silu(x)
def _sigmoid(x):
    return torch.sigmoid(x)
def _layernorm(x, axis=-1, eps=1e-5):
    m = x.mean(dim=axis, keepdim=True)
    v = x.var(dim=axis, keepdim=True, unbiased=False)
    return (x - m) / torch.sqrt(v + eps)
def _scatter_add(tgt, idx, src, axis=0):
    return tgt.clone().index_add_(axis, idx, src)
def _segment_sum(src, seg, n):
    out = torch.zeros((n,) + src.shape[1:], dtype=src.dtype)
    return out.index_add_(0, seg, src)
def _pad(x, pw):
    flat = tuple(v for pair in reversed(pw) for v in pair)
    return torch.nn.functional.pad(x, flat)

kernel_name = 'standalone__mha_block__prompt'

def setup_inputs():

    _w = (lambda a: (lambda t: t.to(torch.bfloat16) if t.is_floating_point() else t)(torch.as_tensor(a)))
    B, S, D, H = 1, 2048, 1024, 32
    return {
        "x": _w((lambda *s: torch.randn(*s, dtype=torch.bfloat16) * 0.2)(B, S, D)),
        "wqkv": _w((lambda *s: torch.randn(*s, dtype=torch.bfloat16) * 0.2)(D, 3 * D)),
        "wo": _w((lambda *s: torch.randn(*s, dtype=torch.bfloat16) * 0.05)(D, D)),
    }

def reference(x, wqkv, wo):
    B, S, D = x.shape
    H = 32
    Dh = D // H
    qkv = (lambda x, *d: x.permute(*d))((x @ wqkv).reshape(B, S, 3, H, Dh), 2, 0, 3, 1, 4)
    q, k, v = qkv[0], qkv[1], qkv[2]
    scores = torch.einsum("bhqd,bhkd->bhqk", q, k) * (Dh ** -0.5)
    p = _softmax(scores, axis=-1)
    o = torch.einsum("bhqk,bhkd->bhqd", p, v)
    return (lambda x, *d: x.permute(*d))(o, 0, 2, 1, 3).reshape(B, S, D) @ wo
```

```asm
; @launch grid=(256,1,1) block=(512,1,1) lds=163840
.amdgcn_target "amdgcn-amd-amdhsa--gfx950"
.text
.globl standalone__mha_block__prompt_kernel
.p2align 8
.type standalone__mha_block__prompt_kernel,@function
standalone__mha_block__prompt_kernel:
    s_cmp_ge_u32 s2, 256
    s_cbranch_scc1 standalone__mha_block__prompt_kernel_end
    s_load_dwordx8 s[4:11], s[0:1], 0
    s_load_dwordx4 s[44:47], s[0:1], 32
    s_getpc_b64 s[40:41]
standalone__mha_block__prompt_kernel_pc:
    v_lshrrev_b32 v1, 6, v0
    v_and_b32 v2, 63, v0
    s_and_b32 s27, s2, 7
    v_readfirstlane_b32 s24, v1
    s_lshr_b32 s28, s2, 3
    s_and_b32 s25, s27, 3
    s_lshl_b32 s25, s25, 2
    s_and_b32 s29, s28, 3
    s_add_u32 s25, s25, s29
    s_lshr_b32 s26, s27, 2
    s_lshl_b32 s26, s26, 3
    s_lshr_b32 s29, s28, 2
    s_add_u32 s26, s26, s29
    v_lshlrev_b32 v12, 4, v2
    v_mov_b32 v13, 0
    s_cmp_ge_u32 s24, 4
    s_cbranch_scc0 standalone__mha_block__prompt_kernel_consumer
    s_sub_u32 s42, s24, 4
    v_lshrrev_b32 v5, 2, v2
    v_and_b32 v5, 7, v5
    v_lshrrev_b32 v6, 5, v2
    v_lshlrev_b32 v6, 6, v6
    v_and_b32 v7, 3, v2
    v_lshlrev_b32 v7, 4, v7
    v_add_u32 v6, v6, v7
    v_lshlrev_b32 v3, 11, v5
    v_add_u32 v3, v3, v6
    v_mul_u32_u24 v4, 6144, v5
    v_add_u32 v4, v4, v6
    s_lshl_b32 s30, s26, 2
    s_add_u32 s30, s30, s42
    s_lshl_b32 s30, s30, 16
    s_mul_i32 s29, s42, 6
    s_lshl_b32 s28, s25, 7
    s_add_u32 s41, s29, 0
    s_lshr_b32 s43, s41, 3
    s_lshl_b32 s43, s43, 11
    s_and_b32 s41, s41, 7
    s_mul_i32 s41, s41, 49152
    s_add_u32 s41, s41, s43
    s_add_u32 s31, s41, s28
    s_add_u32 s41, s29, 1
    s_lshr_b32 s43, s41, 3
    s_lshl_b32 s43, s43, 11
    s_and_b32 s41, s41, 7
    s_mul_i32 s41, s41, 49152
    s_add_u32 s41, s41, s43
    s_add_u32 s32, s41, s28
    s_add_u32 s41, s29, 2
    s_lshr_b32 s43, s41, 3
    s_lshl_b32 s43, s43, 11
    s_and_b32 s41, s41, 7
    s_mul_i32 s41, s41, 49152
    s_add_u32 s41, s41, s43
    s_add_u32 s33, s41, s28
    s_add_u32 s41, s29, 3
    s_lshr_b32 s43, s41, 3
    s_lshl_b32 s43, s43, 11
    s_and_b32 s41, s41, 7
    s_mul_i32 s41, s41, 49152
    s_add_u32 s41, s41, s43
    s_add_u32 s34, s41, s28
    s_add_u32 s41, s29, 4
    s_lshr_b32 s43, s41, 3
    s_lshl_b32 s43, s43, 11
    s_and_b32 s41, s41, 7
    s_mul_i32 s41, s41, 49152
    s_add_u32 s41, s41, s43
    s_add_u32 s35, s41, s28
    s_add_u32 s41, s29, 5
    s_lshr_b32 s43, s41, 3
    s_lshl_b32 s43, s43, 11
    s_and_b32 s41, s41, 7
    s_mul_i32 s41, s41, 49152
    s_add_u32 s41, s41, s43
    s_add_u32 s36, s41, s28
    s_mov_b32 s48, 0
    s_and_b32 s48, s48, 15
    s_mul_i32 s37, s42, 4224
    s_mul_i32 s38, s42, 6336
    s_add_u32 s38, s38, 16896
    s_mov_b32 s39, 0
    s_mov_b32 s40, 0
    s_mov_b32 s14, 4194304
    s_mov_b32 s15, 0x20000
    s_mov_b32 s18, 6291456
    s_mov_b32 s19, 0x20000
    s_waitcnt lgkmcnt(0)
    s_mov_b32 s12, s4
    s_mov_b32 s13, s5
    s_mov_b32 s16, s6
    s_mov_b32 s17, s7
standalone__mha_block__prompt_kernel_ppro:
    s_lshl_b32 s49, s48, 7
    v_add_u32 v8, s49, v3
    s_mul_i32 s49, s48, 393216
    v_add_u32 v9, s49, v4
    s_add_u32 s48, s48, 1
    s_and_b32 s48, s48, 15
    s_add_u32 s43, s37, s39
    s_add_u32 s42, s38, s39
    s_add_u32 m0, s43, 0
    s_add_u32 s41, s30, 0
    buffer_load_dwordx4 v8, s[12:15], s41 offen  lds
    s_add_u32 m0, s43, 1056
    s_add_u32 s41, s30, 16384
    buffer_load_dwordx4 v8, s[12:15], s41 offen  lds
    s_add_u32 m0, s43, 2112
    s_add_u32 s41, s30, 32768
    buffer_load_dwordx4 v8, s[12:15], s41 offen  lds
    s_add_u32 m0, s43, 3168
    s_add_u32 s41, s30, 49152
    buffer_load_dwordx4 v8, s[12:15], s41 offen  lds
    s_add_u32 m0, s42, 0
    s_nop 0
    buffer_load_dwordx4 v9, s[16:19], s31 offen  lds
    s_add_u32 m0, s42, 1056
    s_nop 0
    buffer_load_dwordx4 v9, s[16:19], s32 offen  lds
    s_add_u32 m0, s42, 2112
    s_nop 0
    buffer_load_dwordx4 v9, s[16:19], s33 offen  lds
    s_add_u32 m0, s42, 3168
    s_nop 0
    buffer_load_dwordx4 v9, s[16:19], s34 offen  lds
    s_add_u32 m0, s42, 4224
    s_nop 0
    buffer_load_dwordx4 v9, s[16:19], s35 offen  lds
    s_add_u32 m0, s42, 5280
    s_nop 0
    buffer_load_dwordx4 v9, s[16:19], s36 offen  lds
    s_add_u32 s39, s39, 42240
    s_add_u32 s40, s40, 1
    s_cmp_lt_u32 s40, 2
    s_cbranch_scc1 standalone__mha_block__prompt_kernel_ppro
    s_and_b32 s59, s24, 3
    s_and_b32 s52, s26, 7
    s_lshl_b32 s52, s52, 2
    s_and_b32 s53, s25, 3
    s_add_u32 s52, s52, s53
    s_lshr_b32 s53, s25, 2
    s_lshr_b32 s54, s26, 3
    s_lshl_b32 s55, s54, 10
    s_lshl_b32 s56, s53, 8
    s_add_u32 s55, s55, s56
    s_lshl_b32 s56, s52, 3
    s_add_u32 s55, s55, s56
    v_lshrrev_b32 v10, 2, v2
    v_add_u32 v10, s55, v10
    v_lshlrev_b32 v10, 11, v10
    v_and_b32 v16, 3, v2
    v_lshlrev_b32 v16, 7, v16
    v_add_u32 v10, v10, v16
    s_sub_u32 s55, s59, 1
    s_lshl_b32 s55, s55, 4
    v_and_b32 v16, 15, v2
    v_add_u32 v16, s55, v16
    v_mul_u32_u24 v17, 43, v16
    v_lshrrev_b32 v17, 9, v17
    v_mul_u32_u24 v18, 12, v17
    v_sub_u32 v16, v16, v18
    s_lshl_b32 s55, s54, 7
    s_lshl_b32 s56, s52, 2
    s_add_u32 s55, s55, s56
    v_cmp_le_u32 vcc, 16, v2
    v_and_b32 v18, 3, v2
    v_cndmask_b32 v17, v17, v18, vcc
    s_sub_u32 s56, s59, 1
    s_lshl_b32 s56, s56, 2
    s_add_u32 s56, s56, 3
    v_mov_b32 v18, s56
    v_cndmask_b32 v16, v16, v18, vcc
    v_add_u32 v17, s55, v17
    v_and_b32 v18, 16, v2
    v_lshlrev_b32 v18, 3, v18
    v_xor_b32 v17, v17, v18
    v_mul_u32_u24 v17, 6144, v17
    v_lshrrev_b32 v18, 2, v16
    v_lshlrev_b32 v18, 11, v18
    v_add_u32 v17, v17, v18
    v_and_b32 v16, 3, v16
    v_lshlrev_b32 v16, 7, v16
    v_add_u32 v17, v17, v16
    s_lshl_b32 s55, s53, 9
    v_add_u32 v17, s55, v17
    s_cmp_eq_u32 s59, 0
    s_cselect_b64 vcc, -1, 0
    v_cndmask_b32 v10, v17, v10, vcc
    s_cselect_b32 s56, s4, s6
    s_cselect_b32 s57, s5, s7
    s_mov_b32 s58, 4194304
    s_cselect_b32 s58, s58, 6291456
    s_mov_b32 s59, 0x20000
    s_mov_b32 s55, 512
    s_cselect_b32 s55, s55, 1572864
    s_mov_b32 s52, 0xfffff
    s_cselect_b32 s52, -1, s52
    s_mov_b32 s53, 0
    s_mov_b32 s54, 0
    s_mul_i32 s54, s55, 1
    s_branch standalone__mha_block__prompt_kernel_pnorm
standalone__mha_block__prompt_kernel_ploop:
    s_lshl_b32 s49, s48, 7
    v_add_u32 v8, s49, v3
    s_mul_i32 s49, s48, 393216
    v_add_u32 v9, s49, v4
    s_add_u32 s48, s48, 1
    s_and_b32 s48, s48, 15
    s_add_u32 s43, s37, s39
    s_add_u32 s42, s38, s39
    s_add_u32 m0, s43, 0
    s_add_u32 s41, s30, 0
    buffer_load_dwordx4 v8, s[12:15], s41 offen  lds
    s_add_u32 m0, s43, 1056
    s_add_u32 s41, s30, 16384
    buffer_load_dwordx4 v8, s[12:15], s41 offen  lds
    s_add_u32 m0, s43, 2112
    s_add_u32 s41, s30, 32768
    buffer_load_dwordx4 v8, s[12:15], s41 offen  lds
    s_add_u32 m0, s43, 3168
    s_add_u32 s41, s30, 49152
    buffer_load_dwordx4 v8, s[12:15], s41 offen  lds
    s_add_u32 m0, s42, 0
    s_nop 0
    buffer_load_dwordx4 v9, s[16:19], s31 offen  lds
    s_add_u32 m0, s42, 1056
    s_nop 0
    buffer_load_dwordx4 v9, s[16:19], s32 offen  lds
    s_add_u32 m0, s42, 2112
    s_nop 0
    buffer_load_dwordx4 v9, s[16:19], s33 offen  lds
    s_add_u32 m0, s42, 3168
    s_nop 0
    buffer_load_dwordx4 v9, s[16:19], s34 offen  lds
    s_add_u32 m0, s42, 4224
    s_nop 0
    buffer_load_dwordx4 v9, s[16:19], s35 offen  lds
    s_add_u32 m0, s42, 5280
    s_nop 0
    buffer_load_dwordx4 v9, s[16:19], s36 offen  lds
    s_bitcmp1_b32 0x224, s40
    s_cbranch_scc0 standalone__mha_block__prompt_kernel_uqn
    s_mov_b64 exec, s[52:53]
    buffer_load_dword v11, v10, s[56:59], s54 offen
    s_mov_b64 exec, -1
    s_add_u32 s54, s54, s55
standalone__mha_block__prompt_kernel_uqn:
    s_add_u32 s39, s39, 42240
    s_cmp_eq_u32 s39, 126720
    s_cselect_b32 s39, 0, s39
    s_add_u32 s40, s40, 1
standalone__mha_block__prompt_kernel_pnorm:
    s_bitcmp1_b32 0xcd8, s40
    s_cbranch_scc0 standalone__mha_block__prompt_kernel_w10
    s_waitcnt vmcnt(11)
    s_branch standalone__mha_block__prompt_kernel_w11
standalone__mha_block__prompt_kernel_w10:
    s_waitcnt vmcnt(10)
standalone__mha_block__prompt_kernel_w11:
    s_barrier
    s_cmp_lt_u32 s40, 16
    s_cbranch_scc1 standalone__mha_block__prompt_kernel_ploop
    s_waitcnt vmcnt(0)
    s_barrier
    s_barrier
    global_load_dwordx2 v[14:15], v13, s[44:45]
    s_and_b32 s31, s24, 1
    s_lshr_b32 s30, s24, 1
    s_and_b32 s30, s30, 1
    s_lshr_b32 s28, s24, 2
    s_and_b32 s0, s26, 8
    s_xor_b32 s0, s0, 8
    s_lshr_b32 s1, s25, 3
    s_lshl_b32 s1, s1, 2
    s_add_u32 s0, s0, s1
    s_and_b32 s1, s25, 3
    s_add_u32 s0, s0, s1
    s_and_b32 s1, s25, 4
    s_lshl_b32 s1, s1, 1
    s_and_b32 s29, s26, 7
    s_add_u32 s1, s1, s29
    v_mov_b32 v5, 0x3f803f80
    v_lshrrev_b32 v6, 2, v2
    v_and_b32 v6, 1, v6
    v_cmp_eq_u32 vcc, 0, v6
    s_lshl_b32 s34, s31, 1
    s_add_u32 s34, s34, s28
    s_lshl_b32 s34, s34, 13
    s_mov_b32 s58, s34
    s_lshl_b32 s59, s30, 12
    s_lshl_b32 s60, s24, 6
    s_add_u32 s60, s60, 162816
    s_lshl_b32 s35, s31, 14
    v_add_u32 v6, s35, v12
    s_and_b32 s35, s24, 3
    s_lshl_b32 s35, s35, 12
    s_add_u32 s35, s35, 131072
    v_add_u32 v7, s35, v12
    s_lshl_b32 s33, s25, 1
    s_add_u32 s33, s33, s31
    s_lshl_b32 s29, s33, 18
    s_add_u32 s29, s29, 4194304
    s_add_u32 s12, s46, s29
    s_addc_u32 s13, s47, 0
    s_mov_b32 s14, 262144
    s_mov_b32 s15, 0x20000
    s_mov_b32 s16, s46
    s_mov_b32 s17, s47
    s_mov_b32 s18, 16777216
    s_mov_b32 s19, 0x20000
    s_lshl_b32 s57, s28, 1
    s_add_u32 s57, s57, s30
    s_lshl_b32 s4, s57, 12
    s_lshl_b32 s55, s26, 14
    s_add_u32 s55, s55, s4
    s_and_b32 s56, s26, 8
    s_lshl_b32 s56, s56, 14
    s_add_u32 s56, s56, s4
    s_xor_b32 s5, s56, 0x20000
    s_cmp_eq_u32 s56, s55
    s_cselect_b32 s54, 0x4000, 0
    s_add_u32 s56, s56, s54
    s_lshl_b32 s57, s30, 12
    s_add_u32 s57, s57, s34
    s_mov_b32 s54, 0x4000
    v_mov_b32 v244, v12
    v_mov_b32 v245, v12
    v_mov_b32 v246, v12
    v_mov_b32 v247, v12
    s_branch standalone__mha_block__prompt_kernel_p2setup
standalone__mha_block__prompt_kernel_consumer:
    v_lshlrev_b32 v20, 7, v2
    s_lshl_b32 s30, s24, 13
    v_add_u32 v20, s30, v20
    v_min_u32 v20, standalone__mha_block__prompt_kernel_codeend-standalone__mha_block__prompt_kernel_pc-4, v20
    global_load_dword v21, v20, s[40:41]
    s_lshr_b32 s30, s24, 1
    s_and_b32 s31, s24, 1
    v_and_b32 v3, 31, v2
    v_lshrrev_b32 v4, 5, v2
    v_lshlrev_b32 v22, 11, v3
    v_lshlrev_b32 v23, 7, v4
    v_add_u32 v22, v22, v23
    v_lshrrev_b32 v23, 3, v2
    v_lshlrev_b32 v23, 6, v23
    v_and_b32 v24, 7, v2
    v_add_u32 v23, v23, v24
    v_mul_u32_u24 v23, 6144, v23
    s_lshl_b32 s32, s26, 2
    s_and_b32 s33, s25, 3
    s_add_u32 s32, s32, s33
    s_lshl_b32 s32, s32, 16
    s_lshl_b32 s33, s24, 8
    s_add_u32 s32, s32, s33
    s_add_u32 s33, s32, 1024
    s_and_b32 s34, s26, 7
    s_mul_i32 s34, s34, 49152
    s_lshl_b32 s35, s24, 11
    s_add_u32 s34, s34, s35
    s_lshl_b32 s35, s25, 7
    s_add_u32 s34, s34, s35
    s_add_u32 s35, s34, 3145728
    s_waitcnt lgkmcnt(0)
    s_mov_b32 s12, s4
    s_mov_b32 s13, s5
    s_mov_b32 s14, 4194304
    s_mov_b32 s15, 0x20000
    s_mov_b32 s16, s6
    s_mov_b32 s17, s7
    s_mov_b32 s18, 6291456
    s_mov_b32 s19, 0x20000
    s_cmp_eq_u32 s24, 3
    s_cselect_b32 s18, 0, s18
    s_and_b32 s59, s24, 3
    s_and_b32 s52, s26, 7
    s_lshl_b32 s52, s52, 2
    s_and_b32 s53, s25, 3
    s_add_u32 s52, s52, s53
    s_lshr_b32 s53, s25, 2
    s_lshr_b32 s54, s26, 3
    s_lshl_b32 s55, s54, 10
    s_lshl_b32 s56, s53, 8
    s_add_u32 s55, s55, s56
    s_lshl_b32 s56, s52, 3
    s_add_u32 s55, s55, s56
    v_lshrrev_b32 v29, 2, v2
    v_add_u32 v29, s55, v29
    v_lshlrev_b32 v29, 11, v29
    v_and_b32 v30, 3, v2
    v_lshlrev_b32 v30, 7, v30
    v_add_u32 v29, v29, v30
    s_sub_u32 s55, s59, 1
    s_lshl_b32 s55, s55, 4
    v_and_b32 v30, 15, v2
    v_add_u32 v30, s55, v30
    v_mul_u32_u24 v31, 43, v30
    v_lshrrev_b32 v31, 9, v31
    v_mul_u32_u24 v28, 12, v31
    v_sub_u32 v30, v30, v28
    s_lshl_b32 s55, s54, 7
    s_lshl_b32 s56, s52, 2
    s_add_u32 s55, s55, s56
    v_cmp_le_u32 vcc, 16, v2
    v_and_b32 v28, 3, v2
    v_cndmask_b32 v31, v31, v28, vcc
    s_sub_u32 s56, s59, 1
    s_lshl_b32 s56, s56, 2
    s_add_u32 s56, s56, 3
    v_mov_b32 v28, s56
    v_cndmask_b32 v30, v30, v28, vcc
    v_add_u32 v31, s55, v31
    v_and_b32 v28, 16, v2
    v_lshlrev_b32 v28, 3, v28
    v_xor_b32 v31, v31, v28
    v_mul_u32_u24 v31, 6144, v31
    v_lshrrev_b32 v28, 2, v30
    v_lshlrev_b32 v28, 11, v28
    v_add_u32 v31, v31, v28
    v_and_b32 v30, 3, v30
    v_lshlrev_b32 v30, 7, v30
    v_add_u32 v31, v31, v30
    s_lshl_b32 s55, s53, 9
    v_add_u32 v31, s55, v31
    s_cmp_eq_u32 s59, 0
    s_cselect_b64 vcc, -1, 0
    v_cndmask_b32 v29, v31, v29, vcc
    s_cselect_b32 s56, s4, s6
    s_cselect_b32 s57, s5, s7
    s_mov_b32 s58, 4194304
    s_cselect_b32 s58, s58, 6291456
    s_mov_b32 s59, 0x20000
    s_mov_b32 s55, 512
    s_cselect_b32 s55, s55, 1572864
    s_mov_b32 s52, 0xfffff
    s_cselect_b32 s52, -1, s52
    s_mov_b32 s53, 0
    s_mov_b32 s49, 0
    s_mov_b64 exec, s[52:53]
    buffer_load_dword v30, v29, s[56:59], s49 offen
    s_mov_b64 exec, -1
    s_add_u32 s49, s49, s55
    s_mov_b32 s60, s32
    s_mov_b32 s61, s33
    s_mov_b32 s62, s34
    s_mov_b32 s63, s35
    s_or_b32 s54, s2, s24
    s_cmp_eq_u32 s54, 0
    s_cbranch_scc0 standalone__mha_block__prompt_kernel_nononce
    s_memrealtime s[50:51]
    s_waitcnt lgkmcnt(0)
    s_or_b32 s50, s50, 1
    v_mov_b32 v16, s50
    v_mov_b32 v17, s51
    s_mov_b64 exec, 1
    global_store_dwordx2 v13, v[16:17], s[44:45] sc0 sc1
    s_mov_b64 exec, -1
standalone__mha_block__prompt_kernel_nononce:
    v_bfe_u32 v5, v2, 3, 1
    v_mul_u32_u24 v5, 1056, v5
    v_and_b32 v6, 7, v2
    v_lshlrev_b32 v6, 6, v6
    v_add_u32 v5, v5, v6
    v_lshrrev_b32 v6, 4, v2
    v_lshlrev_b32 v6, 4, v6
    v_add_u32 v5, v5, v6
    s_mul_i32 s32, s30, 8448
    v_add_u32 v10, s32, v5
    v_lshrrev_b32 v5, 4, v2
    v_mul_u32_u24 v5, 1056, v5
    v_and_b32 v6, 15, v2
    v_lshrrev_b32 v7, 2, v6
    v_lshlrev_b32 v7, 6, v7
    v_add_u32 v5, v5, v7
    v_and_b32 v7, 3, v6
    v_lshlrev_b32 v7, 3, v7
    v_add_u32 v5, v5, v7
    s_lshl_b32 s32, s31, 9
    s_add_u32 s32, s32, 16896
    v_add_u32 v11, s32, v5
    v_mov_b32 v32, 0
    v_mov_b32 v33, 0
    v_mov_b32 v34, 0
    v_mov_b32 v35, 0
    v_mov_b32 v36, 0
    v_mov_b32 v37, 0
    v_mov_b32 v38, 0
    v_mov_b32 v39, 0
    v_mov_b32 v40, 0
    v_mov_b32 v41, 0
    v_mov_b32 v42, 0
    v_mov_b32 v43, 0
    v_mov_b32 v44, 0
    v_mov_b32 v45, 0
    v_mov_b32 v46, 0
    v_mov_b32 v47, 0
    v_mov_b32 v48, 0
    v_mov_b32 v49, 0
    v_mov_b32 v50, 0
    v_mov_b32 v51, 0
    v_mov_b32 v52, 0
    v_mov_b32 v53, 0
    v_mov_b32 v54, 0
    v_mov_b32 v55, 0
    v_mov_b32 v56, 0
    v_mov_b32 v57, 0
    v_mov_b32 v58, 0
    v_mov_b32 v59, 0
    v_mov_b32 v60, 0
    v_mov_b32 v61, 0
    v_mov_b32 v62, 0
    v_mov_b32 v63, 0
    v_mov_b32 v64, 0
    v_mov_b32 v65, 0
    v_mov_b32 v66, 0
    v_mov_b32 v67, 0
    v_mov_b32 v68, 0
    v_mov_b32 v69, 0
    v_mov_b32 v70, 0
    v_mov_b32 v71, 0
    v_mov_b32 v72, 0
    v_mov_b32 v73, 0
    v_mov_b32 v74, 0
    v_mov_b32 v75, 0
    v_mov_b32 v76, 0
    v_mov_b32 v77, 0
    v_mov_b32 v78, 0
    v_mov_b32 v79, 0
    v_mov_b32 v80, 0
    v_mov_b32 v81, 0
    v_mov_b32 v82, 0
    v_mov_b32 v83, 0
    v_mov_b32 v84, 0
    v_mov_b32 v85, 0
    v_mov_b32 v86, 0
    v_mov_b32 v87, 0
    v_mov_b32 v88, 0
    v_mov_b32 v89, 0
    v_mov_b32 v90, 0
    v_mov_b32 v91, 0
    v_mov_b32 v92, 0
    v_mov_b32 v93, 0
    v_mov_b32 v94, 0
    v_mov_b32 v95, 0
    v_mov_b32 v96, 0
    v_mov_b32 v97, 0
    v_mov_b32 v98, 0
    v_mov_b32 v99, 0
    v_mov_b32 v100, 0
    v_mov_b32 v101, 0
    v_mov_b32 v102, 0
    v_mov_b32 v103, 0
    v_mov_b32 v104, 0
    v_mov_b32 v105, 0
    v_mov_b32 v106, 0
    v_mov_b32 v107, 0
    v_mov_b32 v108, 0
    v_mov_b32 v109, 0
    v_mov_b32 v110, 0
    v_mov_b32 v111, 0
    v_mov_b32 v112, 0
    v_mov_b32 v113, 0
    v_mov_b32 v114, 0
    v_mov_b32 v115, 0
    v_mov_b32 v116, 0
    v_mov_b32 v117, 0
    v_mov_b32 v118, 0
    v_mov_b32 v119, 0
    v_mov_b32 v120, 0
    v_mov_b32 v121, 0
    v_mov_b32 v122, 0
    v_mov_b32 v123, 0
    v_mov_b32 v124, 0
    v_mov_b32 v125, 0
    v_mov_b32 v126, 0
    v_mov_b32 v127, 0
    s_mov_b32 s39, 0
    s_mov_b32 s40, 0
    v_mov_b32 v8, v10
    v_mov_b32 v9, v11
    s_lshl_b32 s61, s25, 1
    s_add_u32 s61, s61, s31
    s_lshl_b32 s61, s61, 6
    s_lshl_b32 s62, s26, 2
    s_add_u32 s61, s61, s62
    s_lshl_b32 s62, s30, 1
    s_add_u32 s61, s61, s62
    s_lshl_b32 s36, s61, 12
    s_add_u32 s36, s36, 4194304
    s_add_u32 s38, s36, 4096
    s_mov_b32 s37, 0x3e8293ee
    s_lshl_b32 s62, s31, 1
    s_add_u32 s62, s62, s30
    s_lshl_b32 s62, s62, 13
    v_add_u32 v3, s62, v12
    s_lshl_b32 s62, s24, 12
    s_add_u32 s62, s62, 131072
    v_add_u32 v4, s62, v12
    s_and_b32 s31, s24, 1
    s_lshr_b32 s30, s24, 1
    s_and_b32 s30, s30, 1
    s_lshr_b32 s28, s24, 2
    s_and_b32 s0, s26, 8
    s_xor_b32 s0, s0, 8
    s_lshr_b32 s1, s25, 3
    s_lshl_b32 s1, s1, 2
    s_add_u32 s0, s0, s1
    s_and_b32 s1, s25, 3
    s_add_u32 s0, s0, s1
    s_and_b32 s1, s25, 4
    s_lshl_b32 s1, s1, 1
    s_and_b32 s29, s26, 7
    s_add_u32 s1, s1, s29
    v_mov_b32 v5, 0x3f803f80
    v_lshrrev_b32 v6, 2, v2
    v_and_b32 v6, 1, v6
    v_cmp_eq_u32 vcc, 0, v6
    s_lshl_b32 s34, s31, 1
    s_add_u32 s34, s34, s28
    s_lshl_b32 s34, s34, 13
    s_mov_b32 s58, s34
    s_lshl_b32 s59, s30, 12
    s_lshl_b32 s60, s24, 6
    s_add_u32 s60, s60, 162816
    s_lshl_b32 s35, s31, 14
    v_add_u32 v6, s35, v12
    s_and_b32 s35, s24, 3
    s_lshl_b32 s35, s35, 12
    s_add_u32 s35, s35, 131072
    v_add_u32 v7, s35, v12
    s_lshl_b32 s33, s25, 1
    s_add_u32 s33, s33, s31
    s_lshl_b32 s29, s33, 18
    s_add_u32 s29, s29, 4194304
    s_add_u32 s12, s46, s29
    s_addc_u32 s13, s47, 0
    s_mov_b32 s14, 262144
    s_mov_b32 s15, 0x20000
    s_mov_b32 s16, s46
    s_mov_b32 s17, s47
    s_mov_b32 s18, 16777216
    s_mov_b32 s19, 0x20000
    s_lshl_b32 s57, s28, 1
    s_add_u32 s57, s57, s30
    s_lshl_b32 s4, s57, 12
    s_lshl_b32 s55, s26, 14
    s_add_u32 s55, s55, s4
    s_and_b32 s56, s26, 8
    s_lshl_b32 s56, s56, 14
    s_add_u32 s56, s56, s4
    s_xor_b32 s5, s56, 0x20000
    s_cmp_eq_u32 s56, s55
    s_cselect_b32 s54, 0x4000, 0
    s_add_u32 s56, s56, s54
    s_lshl_b32 s57, s30, 12
    s_add_u32 s57, s57, s34
    s_mov_b32 s54, 0x4000
    v_mov_b32 v244, v12
    v_mov_b32 v245, v12
    v_mov_b32 v246, v12
    v_mov_b32 v247, v12
    s_mov_b32 s20, s46
    s_mov_b32 s21, s47
    s_mov_b32 s22, 16777216
    s_mov_b32 s23, 0x20000
    s_barrier
    ds_read_b64_tr_b16 v[144:145], v9 offset:0
    ds_read_b64_tr_b16 v[146:147], v9 offset:256
    ds_read_b128 v[128:131], v8 offset:0
    ds_read_b128 v[132:135], v8 offset:2112
    ds_read_b128 v[136:139], v8 offset:4224
    ds_read_b128 v[140:143], v8 offset:6336
    ds_read_b64_tr_b16 v[148:149], v9 offset:32
    ds_read_b64_tr_b16 v[150:151], v9 offset:288
    ds_read_b64_tr_b16 v[152:153], v9 offset:8448
    ds_read_b64_tr_b16 v[154:155], v9 offset:8704
    ds_read_b64_tr_b16 v[156:157], v9 offset:8480
    ds_read_b64_tr_b16 v[158:159], v9 offset:8736
    ds_read_b64_tr_b16 v[160:161], v9 offset:16896
    ds_read_b64_tr_b16 v[162:163], v9 offset:17152
    ds_read_b64_tr_b16 v[164:165], v9 offset:16928
    ds_read_b64_tr_b16 v[166:167], v9 offset:17184
.p2align 6
standalone__mha_block__prompt_kernel_cloop:
    s_waitcnt lgkmcnt(10)
    v_mfma_f32_16x16x32_bf16 v[32:35], v[144:147], v[128:131], v[32:35]
    v_mfma_f32_16x16x32_bf16 v[36:39], v[144:147], v[132:135], v[36:39]
    ds_read_b64_tr_b16 v[184:185], v9 offset:4224
    v_mfma_f32_16x16x32_bf16 v[48:51], v[144:147], v[136:139], v[48:51]
    ds_read_b64_tr_b16 v[186:187], v9 offset:4480
    v_mfma_f32_16x16x32_bf16 v[52:55], v[144:147], v[140:143], v[52:55]
    ds_read_b128 v[168:171], v8 offset:512
    s_waitcnt lgkmcnt(3)
    v_mfma_f32_16x16x32_bf16 v[40:43], v[148:151], v[128:131], v[40:43]
    ds_read_b128 v[172:175], v8 offset:2624
    v_mfma_f32_16x16x32_bf16 v[44:47], v[148:151], v[132:135], v[44:47]
    ds_read_b128 v[176:179], v8 offset:4736
    v_mfma_f32_16x16x32_bf16 v[56:59], v[148:151], v[136:139], v[56:59]
    ds_read_b128 v[180:183], v8 offset:6848
    v_mfma_f32_16x16x32_bf16 v[60:63], v[148:151], v[140:143], v[60:63]
    ds_read_b64_tr_b16 v[188:189], v9 offset:4256
    v_mfma_f32_16x16x32_bf16 v[64:67], v[152:155], v[128:131], v[64:67]
    ds_read_b64_tr_b16 v[190:191], v9 offset:4512
    v_mfma_f32_16x16x32_bf16 v[68:71], v[152:155], v[132:135], v[68:71]
    ds_read_b64_tr_b16 v[192:193], v9 offset:12672
    v_mfma_f32_16x16x32_bf16 v[80:83], v[152:155], v[136:139], v[80:83]
    ds_read_b64_tr_b16 v[194:195], v9 offset:12928
    v_mfma_f32_16x16x32_bf16 v[84:87], v[152:155], v[140:143], v[84:87]
    ds_read_b64_tr_b16 v[196:197], v9 offset:12704
    v_mfma_f32_16x16x32_bf16 v[72:75], v[156:159], v[128:131], v[72:75]
    ds_read_b64_tr_b16 v[198:199], v9 offset:12960
    v_mfma_f32_16x16x32_bf16 v[76:79], v[156:159], v[132:135], v[76:79]
    ds_read_b64_tr_b16 v[200:201], v9 offset:21120
    v_mfma_f32_16x16x32_bf16 v[88:91], v[156:159], v[136:139], v[88:91]
    ds_read_b64_tr_b16 v[202:203], v9 offset:21376
    v_mfma_f32_16x16x32_bf16 v[92:95], v[156:159], v[140:143], v[92:95]
    ds_read_b64_tr_b16 v[204:205], v9 offset:21152
    v_mfma_f32_16x16x32_bf16 v[96:99], v[128:131], v[160:163], v[96:99]
    ds_read_b64_tr_b16 v[206:207], v9 offset:21408
    v_mfma_f32_16x16x32_bf16 v[104:107], v[132:135], v[160:163], v[104:107]
    v_mfma_f32_16x16x32_bf16 v[112:115], v[136:139], v[160:163], v[112:115]
    s_add_u32 s39, s39, 42240
    v_mfma_f32_16x16x32_bf16 v[120:123], v[140:143], v[160:163], v[120:123]
    s_cmp_eq_u32 s39, 126720
    v_mfma_f32_16x16x32_bf16 v[100:103], v[128:131], v[164:167], v[100:103]
    s_cselect_b32 s39, 0, s39
    v_mfma_f32_16x16x32_bf16 v[108:111], v[132:135], v[164:167], v[108:111]
    v_add_u32 v8, s39, v10
    v_mfma_f32_16x16x32_bf16 v[116:119], v[136:139], v[164:167], v[116:119]
    v_add_u32 v9, s39, v11
    v_mfma_f32_16x16x32_bf16 v[124:127], v[140:143], v[164:167], v[124:127]
    s_waitcnt lgkmcnt(10)
    v_mfma_f32_16x16x32_bf16 v[32:35], v[184:187], v[168:171], v[32:35]
.p2align 6
standalone__mha_block__prompt_kernel_cloopr:
    v_mfma_f32_16x16x32_bf16 v[36:39], v[184:187], v[172:175], v[36:39]
    v_mfma_f32_16x16x32_bf16 v[48:51], v[184:187], v[176:179], v[48:51]
    v_mfma_f32_16x16x32_bf16 v[52:55], v[184:187], v[180:183], v[52:55]
    s_waitcnt lgkmcnt(0)
    s_barrier
    ds_read_b64_tr_b16 v[144:145], v9 offset:0
    v_mfma_f32_16x16x32_bf16 v[40:43], v[188:191], v[168:171], v[40:43]
    ds_read_b64_tr_b16 v[146:147], v9 offset:256
    v_mfma_f32_16x16x32_bf16 v[44:47], v[188:191], v[172:175], v[44:47]
    ds_read_b128 v[128:131], v8 offset:0
    v_mfma_f32_16x16x32_bf16 v[56:59], v[188:191], v[176:179], v[56:59]
    ds_read_b128 v[132:135], v8 offset:2112
    v_mfma_f32_16x16x32_bf16 v[60:63], v[188:191], v[180:183], v[60:63]
    ds_read_b128 v[136:139], v8 offset:4224
    v_mfma_f32_16x16x32_bf16 v[64:67], v[192:195], v[168:171], v[64:67]
    ds_read_b128 v[140:143], v8 offset:6336
    v_mfma_f32_16x16x32_bf16 v[68:71], v[192:195], v[172:175], v[68:71]
    ds_read_b64_tr_b16 v[148:149], v9 offset:32
    v_mfma_f32_16x16x32_bf16 v[80:83], v[192:195], v[176:179], v[80:83]
    ds_read_b64_tr_b16 v[150:151], v9 offset:288
    v_mfma_f32_16x16x32_bf16 v[84:87], v[192:195], v[180:183], v[84:87]
    ds_read_b64_tr_b16 v[152:153], v9 offset:8448
    v_mfma_f32_16x16x32_bf16 v[72:75], v[196:199], v[168:171], v[72:75]
    ds_read_b64_tr_b16 v[154:155], v9 offset:8704
    v_mfma_f32_16x16x32_bf16 v[76:79], v[196:199], v[172:175], v[76:79]
    ds_read_b64_tr_b16 v[156:157], v9 offset:8480
    v_mfma_f32_16x16x32_bf16 v[88:91], v[196:199], v[176:179], v[88:91]
    ds_read_b64_tr_b16 v[158:159], v9 offset:8736
    v_mfma_f32_16x16x32_bf16 v[92:95], v[196:199], v[180:183], v[92:95]
    ds_read_b64_tr_b16 v[160:161], v9 offset:16896
    v_mfma_f32_16x16x32_bf16 v[96:99], v[168:171], v[200:203], v[96:99]
    ds_read_b64_tr_b16 v[162:163], v9 offset:17152
    v_mfma_f32_16x16x32_bf16 v[104:107], v[172:175], v[200:203], v[104:107]
    ds_read_b64_tr_b16 v[164:165], v9 offset:16928
    v_mfma_f32_16x16x32_bf16 v[112:115], v[176:179], v[200:203], v[112:115]
    ds_read_b64_tr_b16 v[166:167], v9 offset:17184
    v_mfma_f32_16x16x32_bf16 v[120:123], v[180:183], v[200:203], v[120:123]
    v_mfma_f32_16x16x32_bf16 v[100:103], v[168:171], v[204:207], v[100:103]
    v_mfma_f32_16x16x32_bf16 v[108:111], v[172:175], v[204:207], v[108:111]
    v_mfma_f32_16x16x32_bf16 v[116:119], v[176:179], v[204:207], v[116:119]
    v_mfma_f32_16x16x32_bf16 v[124:127], v[180:183], v[204:207], v[124:127]
    s_waitcnt lgkmcnt(10)
    v_mfma_f32_16x16x32_bf16 v[32:35], v[144:147], v[128:131], v[32:35]
    v_mfma_f32_16x16x32_bf16 v[36:39], v[144:147], v[132:135], v[36:39]
    ds_read_b64_tr_b16 v[184:185], v9 offset:4224
    v_mfma_f32_16x16x32_bf16 v[48:51], v[144:147], v[136:139], v[48:51]
    ds_read_b64_tr_b16 v[186:187], v9 offset:4480
    v_mfma_f32_16x16x32_bf16 v[52:55], v[144:147], v[140:143], v[52:55]
    ds_read_b128 v[168:171], v8 offset:512
    s_waitcnt lgkmcnt(3)
    v_mfma_f32_16x16x32_bf16 v[40:43], v[148:151], v[128:131], v[40:43]
    ds_read_b128 v[172:175], v8 offset:2624
    v_mfma_f32_16x16x32_bf16 v[44:47], v[148:151], v[132:135], v[44:47]
    ds_read_b128 v[176:179], v8 offset:4736
    v_mfma_f32_16x16x32_bf16 v[56:59], v[148:151], v[136:139], v[56:59]
    ds_read_b128 v[180:183], v8 offset:6848
    v_mfma_f32_16x16x32_bf16 v[60:63], v[148:151], v[140:143], v[60:63]
    ds_read_b64_tr_b16 v[188:189], v9 offset:4256
    v_mfma_f32_16x16x32_bf16 v[64:67], v[152:155], v[128:131], v[64:67]
    ds_read_b64_tr_b16 v[190:191], v9 offset:4512
    v_mfma_f32_16x16x32_bf16 v[68:71], v[152:155], v[132:135], v[68:71]
    ds_read_b64_tr_b16 v[192:193], v9 offset:12672
    v_mfma_f32_16x16x32_bf16 v[80:83], v[152:155], v[136:139], v[80:83]
    ds_read_b64_tr_b16 v[194:195], v9 offset:12928
    v_mfma_f32_16x16x32_bf16 v[84:87], v[152:155], v[140:143], v[84:87]
    ds_read_b64_tr_b16 v[196:197], v9 offset:12704
    v_mfma_f32_16x16x32_bf16 v[72:75], v[156:159], v[128:131], v[72:75]
    ds_read_b64_tr_b16 v[198:199], v9 offset:12960
    v_mfma_f32_16x16x32_bf16 v[76:79], v[156:159], v[132:135], v[76:79]
    ds_read_b64_tr_b16 v[200:201], v9 offset:21120
    v_mfma_f32_16x16x32_bf16 v[88:91], v[156:159], v[136:139], v[88:91]
    ds_read_b64_tr_b16 v[202:203], v9 offset:21376
    v_mfma_f32_16x16x32_bf16 v[92:95], v[156:159], v[140:143], v[92:95]
    ds_read_b64_tr_b16 v[204:205], v9 offset:21152
    v_mfma_f32_16x16x32_bf16 v[96:99], v[128:131], v[160:163], v[96:99]
    ds_read_b64_tr_b16 v[206:207], v9 offset:21408
    v_mfma_f32_16x16x32_bf16 v[104:107], v[132:135], v[160:163], v[104:107]
    v_mfma_f32_16x16x32_bf16 v[112:115], v[136:139], v[160:163], v[112:115]
    s_add_u32 s39, s39, 42240
    v_mfma_f32_16x16x32_bf16 v[120:123], v[140:143], v[160:163], v[120:123]
    s_cmp_eq_u32 s39, 126720
    v_mfma_f32_16x16x32_bf16 v[100:103], v[128:131], v[164:167], v[100:103]
    s_cselect_b32 s39, 0, s39
    v_mfma_f32_16x16x32_bf16 v[108:111], v[132:135], v[164:167], v[108:111]
    v_add_u32 v8, s39, v10
    v_mfma_f32_16x16x32_bf16 v[116:119], v[136:139], v[164:167], v[116:119]
    v_add_u32 v9, s39, v11
    v_mfma_f32_16x16x32_bf16 v[124:127], v[140:143], v[164:167], v[124:127]
    s_add_u32 s40, s40, 1
    s_cmp_lt_u32 s40, 15
    s_waitcnt lgkmcnt(10)
    v_mfma_f32_16x16x32_bf16 v[32:35], v[184:187], v[168:171], v[32:35]
    s_cbranch_scc1 standalone__mha_block__prompt_kernel_cloopr
    v_mfma_f32_16x16x32_bf16 v[36:39], v[184:187], v[172:175], v[36:39]
    v_mfma_f32_16x16x32_bf16 v[48:51], v[184:187], v[176:179], v[48:51]
    v_mfma_f32_16x16x32_bf16 v[52:55], v[184:187], v[180:183], v[52:55]
    s_waitcnt lgkmcnt(0)
    s_barrier
    global_load_dwordx2 v[14:15], v13, s[44:45]
    v_mfma_f32_16x16x32_bf16 v[64:67], v[192:195], v[168:171], v[64:67]
    v_mfma_f32_16x16x32_bf16 v[68:71], v[192:195], v[172:175], v[68:71]
    v_mfma_f32_16x16x32_bf16 v[72:75], v[196:199], v[168:171], v[72:75]
    v_mfma_f32_16x16x32_bf16 v[76:79], v[196:199], v[172:175], v[76:79]
    v_mfma_f32_16x16x32_bf16 v[80:83], v[192:195], v[176:179], v[80:83]
    v_mfma_f32_16x16x32_bf16 v[84:87], v[192:195], v[180:183], v[84:87]
    v_mfma_f32_16x16x32_bf16 v[88:91], v[196:199], v[176:179], v[88:91]
    v_mfma_f32_16x16x32_bf16 v[92:95], v[196:199], v[180:183], v[92:95]
    v_mfma_f32_16x16x32_bf16 v[96:99], v[168:171], v[200:203], v[96:99]
    v_cvt_pk_bf16_f32 v208, v64, v65
    v_cvt_pk_bf16_f32 v209, v66, v67
    v_cvt_pk_bf16_f32 v210, v68, v69
    v_cvt_pk_bf16_f32 v211, v70, v71
    v_cvt_pk_bf16_f32 v212, v72, v73
    v_mfma_f32_16x16x32_bf16 v[104:107], v[172:175], v[200:203], v[104:107]
    v_cvt_pk_bf16_f32 v213, v74, v75
    v_cvt_pk_bf16_f32 v214, v76, v77
    v_cvt_pk_bf16_f32 v215, v78, v79
    s_nop 1
    v_permlane16_swap_b32 v208, v210
    v_mfma_f32_16x16x32_bf16 v[100:103], v[168:171], v[204:207], v[100:103]
    v_permlane16_swap_b32 v209, v211
    v_permlane16_swap_b32 v212, v214
    v_permlane16_swap_b32 v213, v215
    s_nop 1
    buffer_store_dwordx4 v[208:211], v12, s[20:23], s36 offen offset:0 sc0 sc1
    v_mfma_f32_16x16x32_bf16 v[108:111], v[172:175], v[204:207], v[108:111]
    buffer_store_dwordx4 v[212:215], v12, s[20:23], s36 offen offset:1024 sc0 sc1
    ds_write_b128 v3, v[208:211] offset:0
    ds_write_b128 v3, v[212:215] offset:1024
    v_mfma_f32_16x16x32_bf16 v[112:115], v[176:179], v[200:203], v[112:115]
    v_cvt_pk_bf16_f32 v224, v80, v81
    v_cvt_pk_bf16_f32 v225, v82, v83
    v_cvt_pk_bf16_f32 v226, v84, v85
    v_cvt_pk_bf16_f32 v227, v86, v87
    v_cvt_pk_bf16_f32 v228, v88, v89
    v_mfma_f32_16x16x32_bf16 v[120:123], v[180:183], v[200:203], v[120:123]
    v_cvt_pk_bf16_f32 v229, v90, v91
    v_cvt_pk_bf16_f32 v230, v92, v93
    v_cvt_pk_bf16_f32 v231, v94, v95
    s_nop 1
    v_permlane16_swap_b32 v224, v226
    v_mfma_f32_16x16x32_bf16 v[116:119], v[176:179], v[204:207], v[116:119]
    v_permlane16_swap_b32 v225, v227
    v_permlane16_swap_b32 v228, v230
    v_permlane16_swap_b32 v229, v231
    s_nop 1
    buffer_store_dwordx4 v[224:227], v12, s[20:23], s38 offen offset:0 sc0 sc1
    v_mfma_f32_16x16x32_bf16 v[124:127], v[180:183], v[204:207], v[124:127]
    buffer_store_dwordx4 v[228:231], v12, s[20:23], s38 offen offset:1024 sc0 sc1
    ds_write_b128 v3, v[224:227] offset:4096
    ds_write_b128 v3, v[228:231] offset:5120
    v_mfma_f32_16x16x32_bf16 v[40:43], v[188:191], v[168:171], v[40:43]
    v_cvt_pk_bf16_f32 v216, v96, v97
    v_cvt_pk_bf16_f32 v217, v98, v99
    v_cvt_pk_bf16_f32 v218, v100, v101
    v_cvt_pk_bf16_f32 v219, v102, v103
    v_cvt_pk_bf16_f32 v220, v104, v105
    v_mfma_f32_16x16x32_bf16 v[44:47], v[188:191], v[172:175], v[44:47]
    v_cvt_pk_bf16_f32 v221, v106, v107
    v_cvt_pk_bf16_f32 v222, v108, v109
    v_cvt_pk_bf16_f32 v223, v110, v111
    s_nop 1
    v_permlane16_swap_b32 v216, v218
    v_mfma_f32_16x16x32_bf16 v[56:59], v[188:191], v[176:179], v[56:59]
    v_permlane16_swap_b32 v217, v219
    v_permlane16_swap_b32 v220, v222
    v_permlane16_swap_b32 v221, v223
    s_nop 1
    buffer_store_dwordx4 v[216:219], v12, s[20:23], s36 offen offset:2048 sc0 sc1
    v_mfma_f32_16x16x32_bf16 v[60:63], v[188:191], v[180:183], v[60:63]
    buffer_store_dwordx4 v[220:223], v12, s[20:23], s36 offen offset:3072 sc0 sc1
    ds_write_b128 v3, v[216:219] offset:2048
    ds_write_b128 v3, v[220:223] offset:3072
    v_cvt_pk_bf16_f32 v232, v112, v113
    v_cvt_pk_bf16_f32 v233, v114, v115
    v_cvt_pk_bf16_f32 v234, v116, v117
    v_cvt_pk_bf16_f32 v235, v118, v119
    v_cvt_pk_bf16_f32 v236, v120, v121
    v_cvt_pk_bf16_f32 v237, v122, v123
    v_cvt_pk_bf16_f32 v238, v124, v125
    v_cvt_pk_bf16_f32 v239, v126, v127
    s_nop 1
    v_permlane16_swap_b32 v232, v234
    v_permlane16_swap_b32 v233, v235
    v_permlane16_swap_b32 v236, v238
    v_permlane16_swap_b32 v237, v239
    s_nop 1
    buffer_store_dwordx4 v[232:235], v12, s[20:23], s38 offen offset:2048 sc0 sc1
    buffer_store_dwordx4 v[236:239], v12, s[20:23], s38 offen offset:3072 sc0 sc1
    ds_write_b128 v3, v[232:235] offset:6144
    ds_write_b128 v3, v[236:239] offset:7168
    v_mul_f32 v32, s37, v32
    v_mul_f32 v33, s37, v33
    v_mul_f32 v34, s37, v34
    v_mul_f32 v35, s37, v35
    v_mul_f32 v36, s37, v36
    v_mul_f32 v37, s37, v37
    v_mul_f32 v38, s37, v38
    v_mul_f32 v39, s37, v39
    v_mul_f32 v40, s37, v40
    v_mul_f32 v41, s37, v41
    v_mul_f32 v42, s37, v42
    v_mul_f32 v43, s37, v43
    v_mul_f32 v44, s37, v44
    v_mul_f32 v45, s37, v45
    v_mul_f32 v46, s37, v46
    v_mul_f32 v47, s37, v47
    v_mul_f32 v48, s37, v48
    v_mul_f32 v49, s37, v49
    v_mul_f32 v50, s37, v50
    v_mul_f32 v51, s37, v51
    v_mul_f32 v52, s37, v52
    v_mul_f32 v53, s37, v53
    v_mul_f32 v54, s37, v54
    v_mul_f32 v55, s37, v55
    v_mul_f32 v56, s37, v56
    v_mul_f32 v57, s37, v57
    v_mul_f32 v58, s37, v58
    v_mul_f32 v59, s37, v59
    v_mul_f32 v60, s37, v60
    v_mul_f32 v61, s37, v61
    v_mul_f32 v62, s37, v62
    v_mul_f32 v63, s37, v63
    v_cvt_pk_bf16_f32 v16, v32, v33
    v_cvt_pk_bf16_f32 v17, v34, v35
    v_cvt_pk_bf16_f32 v18, v36, v37
    v_cvt_pk_bf16_f32 v19, v38, v39
    v_cvt_pk_bf16_f32 v20, v40, v41
    v_cvt_pk_bf16_f32 v21, v42, v43
    v_cvt_pk_bf16_f32 v22, v44, v45
    v_cvt_pk_bf16_f32 v23, v46, v47
    s_nop 1
    v_permlane16_swap_b32 v16, v18
    v_permlane16_swap_b32 v17, v19
    v_permlane16_swap_b32 v20, v22
    v_permlane16_swap_b32 v21, v23
    s_nop 1
    v_cvt_pk_bf16_f32 v24, v48, v49
    v_cvt_pk_bf16_f32 v25, v50, v51
    v_cvt_pk_bf16_f32 v26, v52, v53
    v_cvt_pk_bf16_f32 v27, v54, v55
    v_cvt_pk_bf16_f32 v28, v56, v57
    v_cvt_pk_bf16_f32 v29, v58, v59
    v_cvt_pk_bf16_f32 v30, v60, v61
    v_cvt_pk_bf16_f32 v31, v62, v63
    s_nop 1
    v_permlane16_swap_b32 v24, v26
    v_permlane16_swap_b32 v25, v27
    v_permlane16_swap_b32 v28, v30
    v_permlane16_swap_b32 v29, v31
    s_nop 1
    s_nop 0
    ds_write_b128 v4, v[16:19] offset:0
    ds_write_b128 v4, v[20:23] offset:1024
    ds_write_b128 v4, v[24:27] offset:2048
    ds_write_b128 v4, v[28:31] offset:3072
standalone__mha_block__prompt_kernel_p2setup:
    v_mov_b32 v156, 0xdddddddd
    v_cndmask_b32 v152, 0, v5, vcc
    v_cndmask_b32 v153, 0, v5, vcc
    v_cndmask_b32 v154, v5, 0, vcc
    v_cndmask_b32 v155, v5, 0, vcc
    v_add_u32 v9, s58, v12
    v_add_u32 v208, 4096, v9
    v_subrev_u32 v208, s59, v208
    v_add_u32 v9, s59, v9
    v_and_b32 v210, 15, v2
    v_lshlrev_b32 v210, 2, v210
    v_add_u32 v210, s60, v210
    v_xor_b32 v211, 128, v210
    v_mov_b32 v209, 0
    ds_write_b32 v210, v209
    v_add_u32 v10, 0x10000, v9
    s_waitcnt lgkmcnt(0)
    s_barrier
    s_cmp_eq_u32 s28, 0
    s_cbranch_scc1 standalone__mha_block__prompt_kernel_haveq
    ds_read_b128 v[16:19], v7 offset:0
    ds_read_b128 v[20:23], v7 offset:1024
    ds_read_b128 v[24:27], v7 offset:2048
    ds_read_b128 v[28:31], v7 offset:3072
standalone__mha_block__prompt_kernel_haveq:
    ds_read_b128 v[184:187], v6 offset:0
    ds_read_b128 v[188:191], v6 offset:1024
    ds_read_b128 v[160:163], v9 offset:0
    ds_read_b128 v[164:167], v9 offset:1024
    ds_read_b128 v[176:179], v9 offset:2048
    ds_read_b128 v[180:183], v9 offset:3072
    v_mov_b32 v96, 0
    v_mov_b32 v97, 0
    v_mov_b32 v98, 0
    v_mov_b32 v99, 0
    v_mov_b32 v100, 0
    v_mov_b32 v101, 0
    v_mov_b32 v102, 0
    v_mov_b32 v103, 0
    v_mov_b32 v104, 0
    v_mov_b32 v105, 0
    v_mov_b32 v106, 0
    v_mov_b32 v107, 0
    v_mov_b32 v108, 0
    v_mov_b32 v109, 0
    v_mov_b32 v110, 0
    v_mov_b32 v111, 0
    v_mov_b32 v112, 0
    v_mov_b32 v113, 0
    v_mov_b32 v114, 0
    v_mov_b32 v115, 0
    v_mov_b32 v116, 0
    v_mov_b32 v117, 0
    v_mov_b32 v118, 0
    v_mov_b32 v119, 0
    v_mov_b32 v120, 0
    v_mov_b32 v121, 0
    v_mov_b32 v122, 0
    v_mov_b32 v123, 0
    v_mov_b32 v124, 0
    v_mov_b32 v125, 0
    v_mov_b32 v126, 0
    v_mov_b32 v127, 0
    v_mov_b32 v144, 0
    v_mov_b32 v145, 0
    v_mov_b32 v146, 0
    v_mov_b32 v147, 0
    v_mov_b32 v148, 0
    v_mov_b32 v149, 0
    v_mov_b32 v150, 0
    v_mov_b32 v151, 0
    s_lshl_b32 s62, s25, 2
    s_lshl_b32 s63, s28, 1
    s_add_u32 s62, s62, s63
    s_add_u32 s62, s62, s31
    s_lshl_b32 s62, s62, 4
    s_and_b32 s63, s26, 8
    s_add_u32 s62, s62, s63
    s_lshl_b32 s62, s62, 3
    s_add_u32 s62, s62, 16777216
    v_and_b32 v3, 7, v2
    v_lshlrev_b32 v3, 3, v3
    v_add_u32 v3, s62, v3
    v_lshrrev_b32 v8, 3, v2
    v_lshlrev_b32 v8, 8, v8
    v_add_u32 v3, v3, v8
    v_xor_b32 v8, 64, v3
    s_waitcnt vmcnt(0)
    s_mov_b32 s63, 0
standalone__mha_block__prompt_kernel_nz:
    v_readfirstlane_b32 s50, v14
    v_readfirstlane_b32 s51, v15
    s_add_u32 s63, s63, 1
    s_cmp_lg_u32 s50, 0
    s_cbranch_scc1 standalone__mha_block__prompt_kernel_nzok
    s_cmp_ge_u32 s63, 262144
    s_cbranch_scc1 standalone__mha_block__prompt_kernel_nzok
    global_load_dwordx2 v[14:15], v13, s[44:45] sc1
    s_waitcnt vmcnt(0)
    s_branch standalone__mha_block__prompt_kernel_nz
standalone__mha_block__prompt_kernel_nzok:
    s_cmp_ge_u32 s24, 4
    s_cbranch_scc1 standalone__mha_block__prompt_kernel_noflag
    s_lshl_b32 s62, s25, 2
    s_add_u32 s62, s62, s24
    s_lshl_b32 s62, s62, 4
    s_add_u32 s62, s62, s26
    s_lshl_b32 s62, s62, 3
    s_add_u32 s62, s62, 16777216
    v_mov_b32 v242, s62
    v_mov_b32 v240, s50
    v_mov_b32 v241, s51
    s_mov_b64 exec, 1
    global_store_dwordx2 v242, v[240:241], s[46:47] sc0 sc1
    s_mov_b64 exec, -1
standalone__mha_block__prompt_kernel_noflag:
    s_waitcnt lgkmcnt(4)
    v_mfma_f32_32x32x16_bf16 v[64:79], v[184:187], v[16:19], 0
    v_mfma_f32_32x32x16_bf16 v[80:95], v[184:187], v[24:27], 0
    v_mfma_f32_32x32x16_bf16 v[64:79], v[188:191], v[20:23], v[64:79]
    v_mfma_f32_32x32x16_bf16 v[80:95], v[188:191], v[28:31], v[80:95]
    s_nop 15
    v_max3_f32 v240, v64, v65, v66
    v_max3_f32 v241, v67, v68, v69
    v_max3_f32 v240, v240, v70, v71
    v_max3_f32 v241, v241, v72, v73
    v_max3_f32 v240, v240, v74, v75
    v_max3_f32 v241, v241, v76, v77
    v_max3_f32 v240, v240, v78, v79
    v_max_f32 v240, v240, v241
    v_mov_b32 v241, v240
    s_nop 1
    v_permlane32_swap_b32 v240, v241
    s_nop 1
    v_max_f32 v240, v240, v241
    v_max3_f32 v242, v80, v81, v82
    v_max3_f32 v243, v83, v84, v85
    v_max3_f32 v242, v242, v86, v87
    v_max3_f32 v243, v243, v88, v89
    v_max3_f32 v242, v242, v90, v91
    v_max3_f32 v243, v243, v92, v93
    v_max3_f32 v242, v242, v94, v95
    v_max_f32 v242, v242, v243
    v_mov_b32 v243, v242
    s_nop 1
    v_permlane32_swap_b32 v242, v243
    s_nop 1
    v_max_f32 v242, v242, v243
    v_sub_f32 v32, 0, v240
    v_sub_f32 v48, 0, v242
    v_sub_f32 v33, 0, v240
    v_sub_f32 v49, 0, v242
    v_sub_f32 v34, 0, v240
    v_sub_f32 v50, 0, v242
    v_sub_f32 v35, 0, v240
    v_sub_f32 v51, 0, v242
    v_sub_f32 v36, 0, v240
    v_sub_f32 v52, 0, v242
    v_sub_f32 v37, 0, v240
    v_sub_f32 v53, 0, v242
    v_sub_f32 v38, 0, v240
    v_sub_f32 v54, 0, v242
    v_sub_f32 v39, 0, v240
    v_sub_f32 v55, 0, v242
    v_sub_f32 v40, 0, v240
    v_sub_f32 v56, 0, v242
    v_sub_f32 v41, 0, v240
    v_sub_f32 v57, 0, v242
    v_sub_f32 v42, 0, v240
    v_sub_f32 v58, 0, v242
    v_sub_f32 v43, 0, v240
    v_sub_f32 v59, 0, v242
    v_sub_f32 v44, 0, v240
    v_sub_f32 v60, 0, v242
    v_sub_f32 v45, 0, v240
    v_sub_f32 v61, 0, v242
    v_sub_f32 v46, 0, v240
    v_sub_f32 v62, 0, v242
    v_sub_f32 v47, 0, v240
    v_sub_f32 v63, 0, v242
    s_waitcnt lgkmcnt(0)
    s_nop 0
    v_mfma_f32_32x32x16_bf16 v[64:79], v[160:163], v[16:19], v[32:47]
    v_mfma_f32_32x32x16_bf16 v[64:79], v[164:167], v[20:23], v[64:79]
    s_nop 15
    v_exp_f32 v64, v64
    v_exp_f32 v65, v65
    v_mfma_f32_32x32x16_bf16 v[80:95], v[160:163], v[24:27], v[48:63]
    v_exp_f32 v66, v66
    v_exp_f32 v67, v67
    ds_read_b128 v[168:171], v208 offset:0
    v_exp_f32 v68, v68
    v_mfma_f32_32x32x16_bf16 v[80:95], v[164:167], v[28:31], v[80:95]
    v_exp_f32 v69, v69
    v_exp_f32 v70, v70
    ds_read_b128 v[172:175], v208 offset:1024
    v_exp_f32 v71, v71
    v_exp_f32 v72, v72
    v_exp_f32 v73, v73
    v_exp_f32 v74, v74
    v_exp_f32 v75, v75
    v_exp_f32 v76, v76
    v_exp_f32 v77, v77
    v_exp_f32 v78, v78
    s_nop 3
    v_exp_f32 v79, v79
    v_smfmac_f32_16x16x64_bf16 v[144:147], v[152:155], v[64:71], v156
    v_exp_f32 v80, v80
    s_waitcnt lgkmcnt(0)
    v_exp_f32 v81, v81
    v_mfma_f32_32x32x16_bf16 v[128:143], v[168:171], v[16:19], v[32:47]
    v_exp_f32 v82, v82
    v_exp_f32 v83, v83
    v_exp_f32 v84, v84
    v_mfma_f32_32x32x16_bf16 v[128:143], v[172:175], v[20:23], v[128:143]
    v_exp_f32 v85, v85
    v_exp_f32 v86, v86
    ds_read_b128 v[184:187], v208 offset:2048
    v_exp_f32 v87, v87
    v_smfmac_f32_16x16x64_bf16 v[144:147], v[152:155], v[72:79], v156
    v_exp_f32 v88, v88
    v_exp_f32 v89, v89
    v_smfmac_f32_32x32x32_bf16 v[96:111], v[176:179], v[64:71], v156
    v_exp_f32 v90, v90
    v_exp_f32 v91, v91
    ds_read_b128 v[188:191], v208 offset:3072
    v_exp_f32 v92, v92
    v_smfmac_f32_32x32x32_bf16 v[96:111], v[180:183], v[72:79], v156
    v_exp_f32 v93, v93
    v_exp_f32 v94, v94
    v_exp_f32 v95, v95
    s_cmp_ge_u32 s24, 4
    s_cbranch_scc1 standalone__mha_block__prompt_kernel_nrq
    s_mov_b64 exec, 0xffff
    global_load_dwordx2 v[4:5], v3, s[46:47] sc1
    s_mov_b64 exec, -1
standalone__mha_block__prompt_kernel_nrq:
    v_smfmac_f32_16x16x64_bf16 v[148:151], v[152:155], v[80:87], v156
    v_exp_f32 v128, v128
    v_exp_f32 v129, v129
    v_mfma_f32_32x32x16_bf16 v[192:207], v[168:171], v[24:27], v[48:63]
    v_exp_f32 v130, v130
    v_exp_f32 v131, v131
    v_exp_f32 v132, v132
    v_mfma_f32_32x32x16_bf16 v[192:207], v[172:175], v[28:31], v[192:207]
    v_exp_f32 v133, v133
    v_exp_f32 v134, v134
    v_exp_f32 v135, v135
    v_smfmac_f32_16x16x64_bf16 v[148:151], v[152:155], v[88:95], v156
    v_exp_f32 v136, v136
    v_exp_f32 v137, v137
    v_smfmac_f32_32x32x32_bf16 v[112:127], v[176:179], v[80:87], v156
    v_exp_f32 v138, v138
    v_exp_f32 v139, v139
    v_exp_f32 v140, v140
    v_smfmac_f32_32x32x32_bf16 v[112:127], v[180:183], v[88:95], v156
    v_exp_f32 v141, v141
    v_exp_f32 v142, v142
    v_exp_f32 v143, v143
    v_smfmac_f32_16x16x64_bf16 v[144:147], v[152:155], v[128:135], v156
    v_exp_f32 v192, v192
    s_waitcnt lgkmcnt(0)
    v_exp_f32 v193, v193
    v_exp_f32 v194, v194
    v_exp_f32 v195, v195
    v_exp_f32 v196, v196
    v_exp_f32 v197, v197
    v_exp_f32 v198, v198
    v_exp_f32 v199, v199
    v_smfmac_f32_16x16x64_bf16 v[144:147], v[152:155], v[136:143], v156
    v_exp_f32 v200, v200
    v_exp_f32 v201, v201
    v_smfmac_f32_32x32x32_bf16 v[96:111], v[184:187], v[128:135], v156
    v_exp_f32 v202, v202
    v_exp_f32 v203, v203
    v_exp_f32 v204, v204
    v_smfmac_f32_32x32x32_bf16 v[96:111], v[188:191], v[136:143], v156
    v_exp_f32 v205, v205
    v_exp_f32 v206, v206
    v_exp_f32 v207, v207
    s_cmp_ge_u32 s24, 4
    s_cbranch_scc1 standalone__mha_block__prompt_kernel_ng1
    s_mov_b32 s63, 0
    s_mov_b64 exec, 0xffff
    s_waitcnt vmcnt(0)
standalone__mha_block__prompt_kernel_g1:
    v_cmp_ne_u32 vcc, s50, v4
    v_cmp_ne_u32 s[52:53], s51, v5
    s_add_u32 s63, s63, 1
    s_cmp_ge_u32 s63, 262144
    s_cbranch_scc1 standalone__mha_block__prompt_kernel_g1_x
    s_nop 2
    s_or_b64 s[52:53], vcc, s[52:53]
    s_cbranch_scc0 standalone__mha_block__prompt_kernel_g1_x
    global_load_dwordx2 v[4:5], v3, s[46:47] sc1
    s_waitcnt vmcnt(0)
    s_branch standalone__mha_block__prompt_kernel_g1
standalone__mha_block__prompt_kernel_g1_x:
    s_mov_b64 exec, -1
    s_add_u32 m0, s57, 32768
    s_add_u32 s60, s56, 8192
    buffer_load_dwordx4 v12, s[12:15], s56 offen offset:0 lds
    buffer_load_dwordx4 v12, s[12:15], s56 offen offset:1024 lds
    buffer_load_dwordx4 v12, s[12:15], s56 offen offset:2048 lds
    buffer_load_dwordx4 v12, s[12:15], s56 offen offset:3072 lds
    s_add_u32 m0, s57, 40960
    s_nop 0
    buffer_load_dwordx4 v12, s[12:15], s60 offen offset:0 lds
    buffer_load_dwordx4 v12, s[12:15], s60 offen offset:1024 lds
    buffer_load_dwordx4 v12, s[12:15], s60 offen offset:2048 lds
    buffer_load_dwordx4 v12, s[12:15], s60 offen offset:3072 lds
    s_add_u32 s56, s56, s54
    s_cmp_eq_u32 s56, s55
    s_cselect_b32 s61, s54, 0
    s_add_u32 s56, s56, s61
    s_add_u32 m0, s57, 65536
    s_nop 0
    buffer_load_dwordx4 v12, s[12:15], s56 offen offset:0 lds
    buffer_load_dwordx4 v12, s[12:15], s56 offen offset:1024 lds
    buffer_load_dwordx4 v12, s[12:15], s56 offen offset:2048 lds
    buffer_load_dwordx4 v12, s[12:15], s56 offen offset:3072 lds
    s_add_u32 s56, s56, s54
    s_cmp_eq_u32 s56, s55
    s_cselect_b32 s61, s54, 0
    s_add_u32 s56, s56, s61
    s_add_u32 m0, s57, 98304
    s_nop 0
    buffer_load_dwordx4 v12, s[12:15], s56 offen offset:0 lds
    buffer_load_dwordx4 v12, s[12:15], s56 offen offset:1024 lds
    buffer_load_dwordx4 v12, s[12:15], s56 offen offset:2048 lds
    buffer_load_dwordx4 v12, s[12:15], s56 offen offset:3072 lds
    s_add_u32 s56, s56, s54
    s_cmp_eq_u32 s56, s55
    s_cselect_b32 s61, s54, 0
    s_add_u32 s56, s56, s61
    s_branch standalone__mha_block__prompt_kernel_ng2
standalone__mha_block__prompt_kernel_ng1:
    s_add_u32 s56, s56, s54
    s_cmp_eq_u32 s56, s55
    s_cselect_b32 s61, s54, 0
    s_add_u32 s56, s56, s61
standalone__mha_block__prompt_kernel_ng2:
    s_and_b32 s34, s25, 3
    s_lshl_b32 s34, s34, 19
    s_lshl_b32 s35, s1, 7
    s_add_u32 s34, s34, s35
    s_lshl_b32 s35, s24, 16
    s_add_u32 s34, s34, s35
    v_lshlrev_b32 v3, 11, v2
    v_and_b32 v3, 0xffff, v3
    s_mov_b32 s20, s8
    s_mov_b32 s21, s9
    s_mov_b32 s22, 2097152
    s_mov_b32 s23, 0x20000
    v_lshrrev_b32 v6, 2, v2
    v_and_b32 v6, 7, v6
    v_lshlrev_b32 v6, 11, v6
    v_lshrrev_b32 v7, 5, v2
    v_lshlrev_b32 v7, 6, v7
    v_add_u32 v7, v6, v7
    v_and_b32 v6, 3, v2
    v_lshlrev_b32 v6, 4, v6
    v_add_u32 v7, v7, v6
    s_and_b32 s27, s24, 3
    s_lshl_b32 s60, s24, 12
    s_add_u32 s60, s60, 65536
    v_add_u32 v232, s60, v12
    s_xor_b32 s61, s24, 4
    s_lshl_b32 s60, s61, 12
    s_add_u32 s60, s60, 65536
    v_add_u32 v233, s60, v12
    s_add_u32 s61, s61, 120
    s_lshl_b32 s61, s61, 10
    v_lshlrev_b32 v5, 2, v2
    v_add_u32 v213, s61, v5
    s_add_u32 s32, s24, 120
    s_lshl_b32 s7, s32, 14
    s_lshl_b32 s32, s32, 10
    v_add_u32 v214, s32, v5
    s_lshl_b32 s60, s1, 7
    s_add_u32 s7, s7, s60
    s_lshl_b32 s62, s0, 2
    s_add_u32 s62, s62, s27
    s_lshl_b32 s62, s62, 5
    s_lshl_b32 s63, s28, 4
    s_add_u32 s62, s62, s63
    s_lshl_b32 s37, s62, 11
    s_add_u32 s37, s37, 12582912
    s_lshl_b32 s62, s62, 3
    s_add_u32 s62, s62, 16785408
    v_lshlrev_b32 v5, 3, v2
    v_add_u32 v234, s62, v5
    s_lshl_b32 s3, s26, 2
    s_lshl_b32 s41, s30, 1
    s_add_u32 s41, s41, s28
    s_add_u32 s3, s3, s41
    s_lshl_b32 s3, s3, 5
    s_add_u32 s3, s3, s33
    s_lshl_b32 s3, s3, 11
    s_add_u32 s3, s3, 12582912
    s_lshl_b32 s60, s31, 2
    s_add_u32 s41, s41, s60
    s_lshl_b32 s62, s26, 10
    s_lshl_b32 s63, s25, 4
    s_add_u32 s62, s62, s63
    s_add_u32 s62, s62, 16785408
    v_and_b32 v5, 3, v2
    v_lshlrev_b32 v5, 8, v5
    v_lshrrev_b32 v6, 2, v2
    v_lshlrev_b32 v6, 3, v6
    v_add3_u32 v235, v5, v6, s62
    v_mov_b32 v240, s50
    v_mov_b32 v241, s51
    s_waitcnt vmcnt(8)
    s_barrier
    ds_read_b128 v[160:163], v9 offset:32768
    ds_read_b128 v[164:167], v9 offset:33792
    ds_read_b128 v[176:179], v9 offset:34816
    ds_read_b128 v[180:183], v9 offset:35840
    s_mov_b32 s58, 0
    s_mov_b32 s59, 0
    s_lshl_b32 s48, s24, 10
    s_add_u32 s48, s48, 122880
    s_add_u32 s49, s24, 56
    s_lshl_b32 s49, s49, 14
    s_lshl_b32 s61, s1, 7
    s_add_u32 s49, s49, s61
    s_mov_b64 s[42:43], 0
    s_cmp_eq_u32 s24, 7
    s_cselect_b32 s6, 3, 4
    s_cmp_ge_u32 s24, 4
    s_cbranch_scc0 standalone__mha_block__prompt_kernel_ng3
    s_add_u32 m0, s57, 65536
    s_nop 0
    buffer_load_dwordx4 v12, s[12:15], s56 offen offset:0 lds
    buffer_load_dwordx4 v12, s[12:15], s56 offen offset:1024 lds
    buffer_load_dwordx4 v12, s[12:15], s56 offen offset:2048 lds
    buffer_load_dwordx4 v12, s[12:15], s56 offen offset:3072 lds
    s_add_u32 s56, s56, s54
    s_cmp_eq_u32 s56, s55
    s_cselect_b32 s61, s54, 0
    s_add_u32 s56, s56, s61
    s_add_u32 m0, s57, 98304
    s_nop 0
    buffer_load_dwordx4 v12, s[12:15], s56 offen offset:0 lds
    buffer_load_dwordx4 v12, s[12:15], s56 offen offset:1024 lds
    buffer_load_dwordx4 v12, s[12:15], s56 offen offset:2048 lds
    buffer_load_dwordx4 v12, s[12:15], s56 offen offset:3072 lds
    s_add_u32 s56, s56, s54
    s_cmp_eq_u32 s56, s55
    s_cselect_b32 s61, s54, 0
    s_add_u32 s56, s56, s61
standalone__mha_block__prompt_kernel_ng3:
    s_waitcnt lgkmcnt(2)
    v_mfma_f32_32x32x16_bf16 v[64:79], v[160:163], v[16:19], v[32:47]
    v_mfma_f32_32x32x16_bf16 v[64:79], v[164:167], v[20:23], v[64:79]
    s_nop 15
    s_branch standalone__mha_block__prompt_kernel_l2
.p2align 6
standalone__mha_block__prompt_kernel_loop:
    s_setprio 3
    v_smfmac_f32_16x16x64_bf16 v[148:151], v[152:155], v[192:199], v156
    v_exp_f32 v64, v64
    v_exp_f32 v65, v65
    v_mfma_f32_32x32x16_bf16 v[80:95], v[160:163], v[24:27], v[48:63]
    s_waitcnt lgkmcnt(0)
    v_readfirstlane_b32 s63, v212
    s_cmp_ge_u32 s63, s58
    s_cbranch_scc0 standalone__mha_block__prompt_kernel_pwp
    standalone__mha_block__prompt_kernel_pwr:
    v_exp_f32 v66, v66
    s_add_u32 s60, s57, s59
    s_add_u32 m0, s60, 0
    v_exp_f32 v67, v67
    ds_read_b128 v[168:171], v208 offset:0
    buffer_load_dwordx4 v244, s[12:15], s56 offen offset:0 lds
    v_exp_f32 v68, v68
    v_mfma_f32_32x32x16_bf16 v[80:95], v[164:167], v[28:31], v[80:95]
    v_exp_f32 v69, v69
    v_exp_f32 v70, v70
    ds_read_b128 v[172:175], v208 offset:1024
    v_exp_f32 v71, v71
    v_smfmac_f32_16x16x64_bf16 v[148:151], v[152:155], v[200:207], v156
    buffer_load_dwordx4 v245, s[12:15], s56 offen offset:1024 lds
    v_exp_f32 v72, v72
    buffer_load_dwordx4 v246, s[12:15], s56 offen offset:2048 lds
    v_exp_f32 v73, v73
    v_smfmac_f32_32x32x32_bf16 v[112:127], v[184:187], v[192:199], v156
    v_exp_f32 v74, v74
    v_exp_f32 v75, v75
    buffer_load_dwordx4 v247, s[12:15], s56 offen offset:3072 lds
    s_add_u32 s56, s56, s54
    s_cmp_eq_u32 s56, s55
    s_cselect_b32 s61, s54, 0
    s_add_u32 s56, s56, s61
    v_exp_f32 v76, v76
    v_smfmac_f32_32x32x32_bf16 v[112:127], v[188:191], v[200:207], v156
    v_exp_f32 v77, v77
    v_exp_f32 v78, v78
    v_exp_f32 v79, v79
    v_smfmac_f32_16x16x64_bf16 v[144:147], v[152:155], v[64:71], v156
    v_exp_f32 v80, v80
    s_waitcnt lgkmcnt(0)
    v_exp_f32 v81, v81
    v_mfma_f32_32x32x16_bf16 v[128:143], v[168:171], v[16:19], v[32:47]
    v_exp_f32 v82, v82
    s_add_u32 s60, s57, s59
    s_add_u32 m0, s60, 32768
    v_exp_f32 v83, v83
    buffer_load_dwordx4 v244, s[12:15], s56 offen offset:0 lds
    v_exp_f32 v84, v84
    v_mfma_f32_32x32x16_bf16 v[128:143], v[172:175], v[20:23], v[128:143]
    v_exp_f32 v85, v85
    v_exp_f32 v86, v86
    ds_read_b128 v[184:187], v208 offset:2048
    buffer_load_dwordx4 v245, s[12:15], s56 offen offset:1024 lds
    v_exp_f32 v87, v87
    v_smfmac_f32_16x16x64_bf16 v[144:147], v[152:155], v[72:79], v156
    v_exp_f32 v88, v88
    buffer_load_dwordx4 v246, s[12:15], s56 offen offset:2048 lds
    v_exp_f32 v89, v89
    v_smfmac_f32_32x32x32_bf16 v[96:111], v[176:179], v[64:71], v156
    v_exp_f32 v90, v90
    v_exp_f32 v91, v91
    ds_read_b128 v[188:191], v208 offset:3072
    buffer_load_dwordx4 v247, s[12:15], s56 offen offset:3072 lds
    s_add_u32 s56, s56, s54
    s_cmp_eq_u32 s56, s55
    s_cselect_b32 s61, s54, 0
    s_add_u32 s56, s56, s61
    v_exp_f32 v92, v92
    v_smfmac_f32_32x32x32_bf16 v[96:111], v[180:183], v[72:79], v156
    v_exp_f32 v93, v93
    v_exp_f32 v94, v94
    v_exp_f32 v95, v95
    s_setprio 2
    v_smfmac_f32_16x16x64_bf16 v[148:151], v[152:155], v[80:87], v156
    v_exp_f32 v128, v128
    v_exp_f32 v129, v129
    v_mfma_f32_32x32x16_bf16 v[192:207], v[168:171], v[24:27], v[48:63]
    v_exp_f32 v130, v130
    v_exp_f32 v131, v131
    ds_read_b128 v[160:163], v9 offset:32768
    v_exp_f32 v132, v132
    v_mfma_f32_32x32x16_bf16 v[192:207], v[172:175], v[28:31], v[192:207]
    v_exp_f32 v133, v133
    v_exp_f32 v134, v134
    ds_read_b128 v[164:167], v9 offset:33792
    s_mov_b32 m0, s48
    v_exp_f32 v135, v135
    v_smfmac_f32_16x16x64_bf16 v[148:151], v[152:155], v[88:95], v156
    s_mov_b64 exec, s[42:43]
    buffer_load_dwordx4 v7, s[20:23], s49 offen  lds
    s_mov_b64 exec, -1
    v_exp_f32 v136, v136
    s_add_u32 s48, s48, 8192
    s_add_u32 s49, s49, 131072
    v_exp_f32 v137, v137
    v_smfmac_f32_32x32x32_bf16 v[112:127], v[176:179], v[80:87], v156
    v_exp_f32 v138, v138
    v_exp_f32 v139, v139
    v_exp_f32 v140, v140
    v_smfmac_f32_32x32x32_bf16 v[112:127], v[180:183], v[88:95], v156
    v_exp_f32 v141, v141
    v_exp_f32 v142, v142
    v_exp_f32 v143, v143
    v_smfmac_f32_16x16x64_bf16 v[144:147], v[152:155], v[128:135], v156
    v_exp_f32 v192, v192
    s_waitcnt lgkmcnt(0)
    v_exp_f32 v193, v193
    v_mfma_f32_32x32x16_bf16 v[64:79], v[160:163], v[16:19], v[32:47]
    v_exp_f32 v194, v194
    v_exp_f32 v195, v195
    v_exp_f32 v196, v196
    v_mfma_f32_32x32x16_bf16 v[64:79], v[164:167], v[20:23], v[64:79]
    v_exp_f32 v197, v197
    v_exp_f32 v198, v198
    ds_read_b128 v[176:179], v9 offset:34816
    v_exp_f32 v199, v199
    v_smfmac_f32_16x16x64_bf16 v[144:147], v[152:155], v[136:143], v156
    v_exp_f32 v200, v200
    v_exp_f32 v201, v201
    v_smfmac_f32_32x32x32_bf16 v[96:111], v[184:187], v[128:135], v156
    v_exp_f32 v202, v202
    v_exp_f32 v203, v203
    ds_read_b128 v[180:183], v9 offset:35840
    v_exp_f32 v204, v204
    v_smfmac_f32_32x32x32_bf16 v[96:111], v[188:191], v[136:143], v156
    v_exp_f32 v205, v205
    v_exp_f32 v206, v206
    v_exp_f32 v207, v207
standalone__mha_block__prompt_kernel_l2:
    s_setprio 1
    v_smfmac_f32_16x16x64_bf16 v[148:151], v[152:155], v[192:199], v156
    v_exp_f32 v64, v64
    v_add_u32 v209, 1, v209
    v_exp_f32 v65, v65
    v_mfma_f32_32x32x16_bf16 v[80:95], v[160:163], v[24:27], v[48:63]
    v_exp_f32 v66, v66
    v_exp_f32 v67, v67
    ds_read_b128 v[168:171], v208 offset:32768
    v_exp_f32 v68, v68
    v_mfma_f32_32x32x16_bf16 v[80:95], v[164:167], v[28:31], v[80:95]
    v_exp_f32 v69, v69
    v_exp_f32 v70, v70
    ds_read_b128 v[172:175], v208 offset:33792
    v_exp_f32 v71, v71
    v_smfmac_f32_16x16x64_bf16 v[148:151], v[152:155], v[200:207], v156
    v_exp_f32 v72, v72
    v_exp_f32 v73, v73
    v_smfmac_f32_32x32x32_bf16 v[112:127], v[184:187], v[192:199], v156
    v_exp_f32 v74, v74
    v_exp_f32 v75, v75
    v_exp_f32 v76, v76
    v_smfmac_f32_32x32x32_bf16 v[112:127], v[188:191], v[200:207], v156
    v_exp_f32 v77, v77
    v_exp_f32 v78, v78
    v_exp_f32 v79, v79
    v_smfmac_f32_16x16x64_bf16 v[144:147], v[152:155], v[64:71], v156
    v_exp_f32 v80, v80
    s_waitcnt lgkmcnt(0)
    v_exp_f32 v81, v81
    v_mfma_f32_32x32x16_bf16 v[128:143], v[168:171], v[16:19], v[32:47]
    v_exp_f32 v82, v82
    v_exp_f32 v83, v83
    v_exp_f32 v84, v84
    v_mfma_f32_32x32x16_bf16 v[128:143], v[172:175], v[20:23], v[128:143]
    v_exp_f32 v85, v85
    v_exp_f32 v86, v86
    ds_read_b128 v[184:187], v208 offset:34816
    v_exp_f32 v87, v87
    v_smfmac_f32_16x16x64_bf16 v[144:147], v[152:155], v[72:79], v156
    v_exp_f32 v88, v88
    v_exp_f32 v89, v89
    v_smfmac_f32_32x32x32_bf16 v[96:111], v[176:179], v[64:71], v156
    v_exp_f32 v90, v90
    v_exp_f32 v91, v91
    ds_read_b128 v[188:191], v208 offset:35840
    v_exp_f32 v92, v92
    v_smfmac_f32_32x32x32_bf16 v[96:111], v[180:183], v[72:79], v156
    v_exp_f32 v93, v93
    v_exp_f32 v94, v94
    v_exp_f32 v95, v95
    s_waitcnt vmcnt(0) lgkmcnt(0)
    ds_write_b32 v210, v209
    s_bitcmp1_b32 0x86, s58
    s_cbranch_scc1 standalone__mha_block__prompt_kernel_g2
standalone__mha_block__prompt_kernel_g2r:
    s_setprio 0
    v_smfmac_f32_16x16x64_bf16 v[148:151], v[152:155], v[80:87], v156
    v_exp_f32 v128, v128
    v_exp_f32 v129, v129
    v_mfma_f32_32x32x16_bf16 v[192:207], v[168:171], v[24:27], v[48:63]
    v_exp_f32 v130, v130
    v_exp_f32 v131, v131
    ds_read_b128 v[160:163], v10 offset:0
    v_exp_f32 v132, v132
    v_mfma_f32_32x32x16_bf16 v[192:207], v[172:175], v[28:31], v[192:207]
    v_exp_f32 v133, v133
    v_exp_f32 v134, v134
    ds_read_b128 v[164:167], v10 offset:1024
    v_exp_f32 v135, v135
    v_smfmac_f32_16x16x64_bf16 v[148:151], v[152:155], v[88:95], v156
    v_exp_f32 v136, v136
    v_exp_f32 v137, v137
    v_smfmac_f32_32x32x32_bf16 v[112:127], v[176:179], v[80:87], v156
    v_exp_f32 v138, v138
    v_exp_f32 v139, v139
    v_exp_f32 v140, v140
    v_smfmac_f32_32x32x32_bf16 v[112:127], v[180:183], v[88:95], v156
    v_exp_f32 v141, v141
    v_exp_f32 v142, v142
    v_exp_f32 v143, v143
    v_smfmac_f32_16x16x64_bf16 v[144:147], v[152:155], v[128:135], v156
    v_exp_f32 v192, v192
    s_waitcnt lgkmcnt(0)
    v_exp_f32 v193, v193
    v_mfma_f32_32x32x16_bf16 v[64:79], v[160:163], v[16:19], v[32:47]
    v_exp_f32 v194, v194
    v_exp_f32 v195, v195
    v_exp_f32 v196, v196
    v_mfma_f32_32x32x16_bf16 v[64:79], v[164:167], v[20:23], v[64:79]
    v_exp_f32 v197, v197
    v_exp_f32 v198, v198
    ds_read_b128 v[176:179], v10 offset:2048
    v_exp_f32 v199, v199
    v_smfmac_f32_16x16x64_bf16 v[144:147], v[152:155], v[136:143], v156
    v_exp_f32 v200, v200
    ds_read_b32 v212, v211
    v_exp_f32 v201, v201
    v_smfmac_f32_32x32x32_bf16 v[96:111], v[184:187], v[128:135], v156
    v_exp_f32 v202, v202
    v_exp_f32 v203, v203
    ds_read_b128 v[180:183], v10 offset:3072
    v_exp_f32 v204, v204
    v_smfmac_f32_32x32x32_bf16 v[96:111], v[188:191], v[136:143], v156
    v_exp_f32 v205, v205
    v_exp_f32 v206, v206
    v_exp_f32 v207, v207
    v_xor_b32 v9, 0x10000, v9
    v_xor_b32 v10, 0x10000, v10
    v_xor_b32 v208, 0x10000, v208
    s_and_b32 s59, s58, 1
    s_lshl_b32 s59, s59, 16
    s_sub_u32 s61, s58, 1
    s_add_u32 s58, s58, 1
    s_cmp_lt_u32 s61, s6
    s_cselect_b64 s[42:43], -1, 0
    s_cmp_eq_u32 s58, 3
    s_cselect_b32 s56, s5, s56
    s_cmp_eq_u32 s58, 7
    s_cbranch_scc0 standalone__mha_block__prompt_kernel_loop
    s_branch standalone__mha_block__prompt_kernel_wosw
standalone__mha_block__prompt_kernel_last:
    s_mul_i32 s60, s24, 3
    s_add_u32 s60, s60, 96
    s_lshl_b32 s48, s60, 10
    s_lshl_b32 s60, s60, 14
    s_lshl_b32 s29, s1, 7
    s_add_u32 s49, s60, s29
    s_barrier
    s_add_u32 s60, s29, 1556480
    s_mov_b32 m0, 162816
    s_cmp_eq_u32 s24, 7
    s_cselect_b64 exec, -1, 0
    buffer_load_dwordx4 v7, s[20:23], s60 offen  lds
    s_mov_b64 exec, -1
    s_setprio 0
    v_smfmac_f32_16x16x64_bf16 v[148:151], v[152:155], v[80:87], v156
    v_exp_f32 v128, v128
    v_exp_f32 v129, v129
    v_mfma_f32_32x32x16_bf16 v[192:207], v[168:171], v[24:27], v[48:63]
    s_add_u32 m0, s48, 0
    s_add_u32 s60, s49, 0
    v_exp_f32 v130, v130
    buffer_load_dwordx4 v7, s[20:23], s60 offen  lds
    v_exp_f32 v131, v131
    v_exp_f32 v132, v132
    v_mfma_f32_32x32x16_bf16 v[192:207], v[172:175], v[28:31], v[192:207]
    v_exp_f32 v133, v133
    v_exp_f32 v134, v134
    s_add_u32 m0, s48, 1024
    s_add_u32 s60, s49, 16384
    v_exp_f32 v135, v135
    v_smfmac_f32_16x16x64_bf16 v[148:151], v[152:155], v[88:95], v156
    buffer_load_dwordx4 v7, s[20:23], s60 offen  lds
    v_exp_f32 v136, v136
    v_exp_f32 v137, v137
    v_smfmac_f32_32x32x32_bf16 v[112:127], v[176:179], v[80:87], v156
    v_exp_f32 v138, v138
    v_exp_f32 v139, v139
    s_add_u32 m0, s48, 2048
    s_add_u32 s60, s49, 32768
    v_exp_f32 v140, v140
    v_smfmac_f32_32x32x32_bf16 v[112:127], v[180:183], v[88:95], v156
    buffer_load_dwordx4 v7, s[20:23], s60 offen  lds
    v_exp_f32 v141, v141
    v_exp_f32 v142, v142
    v_exp_f32 v143, v143
    v_smfmac_f32_16x16x64_bf16 v[144:147], v[152:155], v[128:135], v156
    v_exp_f32 v192, v192
    v_exp_f32 v193, v193
    v_exp_f32 v194, v194
    v_exp_f32 v195, v195
    v_exp_f32 v196, v196
    v_exp_f32 v197, v197
    v_exp_f32 v198, v198
    v_exp_f32 v199, v199
    v_smfmac_f32_16x16x64_bf16 v[144:147], v[152:155], v[136:143], v156
    v_exp_f32 v200, v200
    v_exp_f32 v201, v201
    v_smfmac_f32_32x32x32_bf16 v[96:111], v[184:187], v[128:135], v156
    v_exp_f32 v202, v202
    v_exp_f32 v203, v203
    v_exp_f32 v204, v204
    v_smfmac_f32_32x32x32_bf16 v[96:111], v[188:191], v[136:143], v156
    v_exp_f32 v205, v205
    v_exp_f32 v206, v206
    v_exp_f32 v207, v207
    s_setprio 0
    s_nop 1
    v_smfmac_f32_32x32x32_bf16 v[112:127], v[184:187], v[192:199], v156
    v_smfmac_f32_32x32x32_bf16 v[112:127], v[188:191], v[200:207], v156
    v_smfmac_f32_16x16x64_bf16 v[148:151], v[152:155], v[192:199], v156
    v_smfmac_f32_16x16x64_bf16 v[148:151], v[152:155], v[200:207], v156
    s_lshl_b32 s29, s1, 7
    s_cmp_eq_u32 s28, 0
    s_cbranch_scc1 standalone__mha_block__prompt_kernel_k0
    ds_write_b128 v232, v[96:99] offset:0
    ds_write_b128 v232, v[100:103] offset:1024
    ds_write_b128 v232, v[104:107] offset:2048
    ds_write_b128 v232, v[108:111] offset:3072
    ds_write_b32 v213, v144
    s_waitcnt lgkmcnt(0)
    s_barrier
    s_mov_b64 exec, 0xffff
    global_load_dwordx2 v[14:15], v234, s[46:47] sc1
    s_mov_b64 exec, -1
    ds_read_b128 v[64:67], v233 offset:0
    ds_read_b128 v[68:71], v233 offset:1024
    ds_read_b128 v[72:75], v233 offset:2048
    ds_read_b128 v[76:79], v233 offset:3072
    ds_read_b32 v7, v214
    s_mov_b32 m0, s32
    s_mov_b32 s42, 0x4b800000
    s_mov_b32 s43, 0x7b800000
    s_waitcnt lgkmcnt(0)
    buffer_load_dwordx4 v244, s[20:23], s7 offen  lds
    v_add_f32 v112, v112, v64
    v_add_f32 v113, v113, v65
    v_add_f32 v114, v114, v66
    v_add_f32 v115, v115, v67
    v_add_f32 v116, v116, v68
    v_add_f32 v117, v117, v69
    v_add_f32 v118, v118, v70
    v_add_f32 v119, v119, v71
    v_add_f32 v120, v120, v72
    v_add_f32 v121, v121, v73
    v_add_f32 v122, v122, v74
    v_add_f32 v123, v123, v75
    v_add_f32 v124, v124, v76
    v_add_f32 v125, v125, v77
    v_add_f32 v126, v126, v78
    v_add_f32 v127, v127, v79
    v_add_f32 v148, v148, v7
    v_max3_f32 v3, |v112|, |v113|, |v114|
    v_max3_f32 v3, v3, |v115|, |v116|
    v_max3_f32 v3, v3, |v117|, |v118|
    v_max3_f32 v3, v3, |v119|, |v120|
    v_max3_f32 v3, v3, |v121|, |v122|
    v_max3_f32 v3, v3, |v123|, |v124|
    v_max3_f32 v3, v3, |v125|, |v126|
    v_max_f32 v3, v3, |v127|
    v_cmp_nle_f32 vcc, v148, s42
    v_cmp_nle_f32 s[52:53], v3, s43
    v_rcp_f32 v3, v148
    s_nop 2
    s_or_b64 s[52:53], vcc, s[52:53]
    s_cbranch_scc1 standalone__mha_block__prompt_kernel_slowb
    v_mul_f32 v112, v112, v3
    v_mul_f32 v113, v113, v3
    v_mul_f32 v114, v114, v3
    v_mul_f32 v115, v115, v3
    v_mul_f32 v116, v116, v3
    v_mul_f32 v117, v117, v3
    v_mul_f32 v118, v118, v3
    v_mul_f32 v119, v119, v3
    v_mul_f32 v120, v120, v3
    v_mul_f32 v121, v121, v3
    v_mul_f32 v122, v122, v3
    v_mul_f32 v123, v123, v3
    v_mul_f32 v124, v124, v3
    v_mul_f32 v125, v125, v3
    v_mul_f32 v126, v126, v3
    v_mul_f32 v127, v127, v3
    v_cvt_pk_bf16_f32 v224, v112, v113
    v_cvt_pk_bf16_f32 v225, v114, v115
    v_cvt_pk_bf16_f32 v226, v116, v117
    v_cvt_pk_bf16_f32 v227, v118, v119
    v_cvt_pk_bf16_f32 v228, v120, v121
    v_cvt_pk_bf16_f32 v229, v122, v123
    v_cvt_pk_bf16_f32 v230, v124, v125
    v_cvt_pk_bf16_f32 v231, v126, v127
    buffer_store_dwordx4 v[224:227], v12, s[16:19], s3 offen sc0 sc1
    buffer_store_dwordx4 v[228:231], v12, s[16:19], s3 offen offset:1024 sc0 sc1
    s_branch standalone__mha_block__prompt_kernel_osd
standalone__mha_block__prompt_kernel_k0:
    s_nop 7
    ds_write_b128 v232, v[112:115] offset:0
    ds_write_b128 v232, v[116:119] offset:1024
    ds_write_b128 v232, v[120:123] offset:2048
    ds_write_b128 v232, v[124:127] offset:3072
    ds_write_b32 v213, v148
    s_waitcnt lgkmcnt(0)
    s_barrier
    s_mov_b64 exec, 0xffff
    global_load_dwordx2 v[14:15], v234, s[46:47] sc1
    s_mov_b64 exec, -1
    ds_read_b128 v[64:67], v233 offset:0
    ds_read_b128 v[68:71], v233 offset:1024
    ds_read_b128 v[72:75], v233 offset:2048
    ds_read_b128 v[76:79], v233 offset:3072
    ds_read_b32 v7, v214
    s_mov_b32 m0, s32
    s_mov_b32 s42, 0x4b800000
    s_mov_b32 s43, 0x7b800000
    s_waitcnt lgkmcnt(0)
    buffer_load_dwordx4 v244, s[20:23], s7 offen  lds
    v_add_f32 v96, v96, v64
    v_add_f32 v97, v97, v65
    v_add_f32 v98, v98, v66
    v_add_f32 v99, v99, v67
    v_add_f32 v100, v100, v68
    v_add_f32 v101, v101, v69
    v_add_f32 v102, v102, v70
    v_add_f32 v103, v103, v71
    v_add_f32 v104, v104, v72
    v_add_f32 v105, v105, v73
    v_add_f32 v106, v106, v74
    v_add_f32 v107, v107, v75
    v_add_f32 v108, v108, v76
    v_add_f32 v109, v109, v77
    v_add_f32 v110, v110, v78
    v_add_f32 v111, v111, v79
    v_add_f32 v144, v144, v7
    v_max3_f32 v3, |v96|, |v97|, |v98|
    v_max3_f32 v3, v3, |v99|, |v100|
    v_max3_f32 v3, v3, |v101|, |v102|
    v_max3_f32 v3, v3, |v103|, |v104|
    v_max3_f32 v3, v3, |v105|, |v106|
    v_max3_f32 v3, v3, |v107|, |v108|
    v_max3_f32 v3, v3, |v109|, |v110|
    v_max_f32 v3, v3, |v111|
    v_cmp_nle_f32 vcc, v144, s42
    v_cmp_nle_f32 s[52:53], v3, s43
    v_rcp_f32 v3, v144
    s_nop 2
    s_or_b64 s[52:53], vcc, s[52:53]
    s_cbranch_scc1 standalone__mha_block__prompt_kernel_slow
    s_branch standalone__mha_block__prompt_kernel_fin2a
standalone__mha_block__prompt_kernel_fin:
    v_rcp_f32 v3, v144
    s_nop 0
standalone__mha_block__prompt_kernel_fin2a:
    v_mul_f32 v96, v96, v3
    v_mul_f32 v97, v97, v3
    v_mul_f32 v98, v98, v3
    v_mul_f32 v99, v99, v3
    v_mul_f32 v100, v100, v3
    v_mul_f32 v101, v101, v3
    v_mul_f32 v102, v102, v3
    v_mul_f32 v103, v103, v3
    v_mul_f32 v104, v104, v3
    v_mul_f32 v105, v105, v3
    v_mul_f32 v106, v106, v3
    v_mul_f32 v107, v107, v3
    v_mul_f32 v108, v108, v3
    v_mul_f32 v109, v109, v3
    v_mul_f32 v110, v110, v3
    v_mul_f32 v111, v111, v3
    v_cvt_pk_bf16_f32 v224, v96, v97
    v_cvt_pk_bf16_f32 v225, v98, v99
    v_cvt_pk_bf16_f32 v226, v100, v101
    v_cvt_pk_bf16_f32 v227, v102, v103
    v_cvt_pk_bf16_f32 v228, v104, v105
    v_cvt_pk_bf16_f32 v229, v106, v107
    v_cvt_pk_bf16_f32 v230, v108, v109
    v_cvt_pk_bf16_f32 v231, v110, v111
    buffer_store_dwordx4 v[224:227], v12, s[16:19], s3 offen sc0 sc1
    buffer_store_dwordx4 v[228:231], v12, s[16:19], s3 offen offset:1024 sc0 sc1
standalone__mha_block__prompt_kernel_osd:
    s_cmp_eq_u32 s24, 0
    s_cselect_b32 s39, 0, 1
    s_mov_b32 s43, 0
    s_waitcnt vmcnt(3)
    s_mov_b64 exec, 0xffff
    v_cmp_ne_u32 vcc, s50, v14
    v_cmp_ne_u32 s[52:53], s51, v15
    s_nop 3
    s_or_b32 s52, vcc_lo, s52
    s_and_b32 s61, s52, 0xff
    s_cbranch_scc0 standalone__mha_block__prompt_kernel_go0
    s_and_b32 s61, s52, 0xff00
    s_cbranch_scc0 standalone__mha_block__prompt_kernel_go1
    s_waitcnt vmcnt(0)
    s_barrier
    s_mov_b32 s43, 1
    s_cmp_eq_u32 s39, 0
    s_cbranch_scc0 standalone__mha_block__prompt_kernel_nf
    s_mov_b64 exec, 0xff
    global_store_dwordx2 v235, v[240:241], s[46:47] sc0 sc1
    s_mov_b32 s39, 1
    s_mov_b64 exec, 0xffff
standalone__mha_block__prompt_kernel_nf:
    s_mov_b32 s63, 0
standalone__mha_block__prompt_kernel_q1:
    s_sleep 4
    global_load_dwordx2 v[14:15], v234, s[46:47] sc1
    s_add_u32 s63, s63, 1
    s_waitcnt vmcnt(0)
    v_cmp_ne_u32 vcc, s50, v14
    v_cmp_ne_u32 s[52:53], s51, v15
    s_nop 3
    s_or_b32 s52, vcc_lo, s52
    s_and_b32 s61, s52, 0xff
    s_cbranch_scc0 standalone__mha_block__prompt_kernel_go0
    s_and_b32 s61, s52, 0xff00
    s_cbranch_scc0 standalone__mha_block__prompt_kernel_go1
    s_cmp_lt_u32 s63, 262144
    s_cbranch_scc1 standalone__mha_block__prompt_kernel_q1
    s_branch standalone__mha_block__prompt_kernel_go0
standalone__mha_block__prompt_kernel_go1:
    s_add_u32 s36, s37, 16384
    s_mov_b32 s38, 0xff
    s_branch standalone__mha_block__prompt_kernel_go
standalone__mha_block__prompt_kernel_go0:
    s_mov_b32 s36, s37
    s_add_u32 s37, s37, 16384
    s_mov_b32 s38, 0xff00
standalone__mha_block__prompt_kernel_go:
    s_mov_b64 exec, -1
    s_and_b32 s61, s52, s38
    s_cbranch_scc1 standalone__mha_block__prompt_kernel_split
    s_add_u32 s34, s36, 0
    buffer_load_dwordx4 v[64:67], v12, s[16:19], s34 offen offset:0 sc1
    s_add_u32 s34, s36, 0
    buffer_load_dwordx4 v[68:71], v12, s[16:19], s34 offen offset:1024 sc1
    s_add_u32 s34, s36, 2048
    buffer_load_dwordx4 v[72:75], v12, s[16:19], s34 offen offset:0 sc1
    s_add_u32 s34, s36, 2048
    buffer_load_dwordx4 v[76:79], v12, s[16:19], s34 offen offset:1024 sc1
    s_add_u32 s34, s36, 4096
    buffer_load_dwordx4 v[80:83], v12, s[16:19], s34 offen offset:0 sc1
    s_add_u32 s34, s36, 4096
    buffer_load_dwordx4 v[84:87], v12, s[16:19], s34 offen offset:1024 sc1
    v_lshrrev_b32 v4, 5, v2
    v_lshlrev_b32 v4, 8, v4
    v_and_b32 v5, 15, v2
    v_lshrrev_b32 v7, 2, v5
    v_lshlrev_b32 v7, 6, v7
    v_add_u32 v4, v4, v7
    v_and_b32 v7, 3, v5
    v_lshlrev_b32 v7, 3, v7
    v_add_u32 v4, v4, v7
    v_lshrrev_b32 v7, 4, v2
    v_and_b32 v7, 1, v7
    v_lshlrev_b32 v7, 5, v7
    v_add_u32 v4, v4, v7
    s_lshl_b32 s61, s28, 17
    s_lshl_b32 s62, s28, 16
    s_add_u32 s62, s62, 32768
    s_cmp_eq_u32 s38, 0xff00
    s_cselect_b32 s63, s61, s62
    s_cselect_b32 s62, s62, s61
    v_add_u32 v9, s63, v4
    v_add_u32 v10, s62, v4
    s_xor_b32 s61, s24, 4
    s_lshl_b32 s61, s61, 12
    s_add_u32 s61, s61, 65536
    v_lshrrev_b32 v24, 2, v2
    s_lshl_b32 s62, s27, 5
    v_lshlrev_b32 v25, 6, v24
    v_add_u32 v24, s62, v24
    v_lshlrev_b32 v24, 11, v24
    v_and_b32 v26, 3, v2
    v_lshlrev_b32 v27, 4, v26
    v_add_u32 v24, v24, v27
    v_bfe_u32 v27, v2, 3, 2
    v_xor_b32 v26, v26, v27
    v_lshlrev_b32 v26, 4, v26
    v_add3_u32 v25, v25, v26, s61
    v_and_b32 v26, 31, v2
    v_lshlrev_b32 v26, 6, v26
    v_bfe_u32 v27, v2, 1, 2
    v_lshrrev_b32 v28, 5, v2
    v_xor_b32 v27, v27, v28
    v_lshlrev_b32 v27, 4, v27
    v_add3_u32 v26, v26, v27, s61
    v_xor_b32 v27, 32, v26
    s_lshl_b32 s30, s0, 18
    s_add_u32 s30, s30, s29
    s_lshl_b32 s61, s28, 6
    s_add_u32 s30, s30, s61
    s_add_u32 s31, s30, 32768
    s_mov_b32 s20, s10
    s_mov_b32 s21, s11
    s_mov_b32 s22, 4194304
    s_mov_b32 s23, 0x20000
    s_cmp_lg_u32 s43, 0
    s_cbranch_scc1 standalone__mha_block__prompt_kernel_nbb
    s_waitcnt vmcnt(6)
    s_barrier
standalone__mha_block__prompt_kernel_nbb:
    ds_read_b64_tr_b16 v[192:193], v9 offset:0
    ds_read_b64_tr_b16 v[194:195], v9 offset:1024
    ds_read_b64_tr_b16 v[196:197], v9 offset:512
    ds_read_b64_tr_b16 v[198:199], v9 offset:1536
    ds_read_b64_tr_b16 v[200:201], v9 offset:2048
    ds_read_b64_tr_b16 v[202:203], v9 offset:3072
    ds_read_b64_tr_b16 v[204:205], v9 offset:2560
    ds_read_b64_tr_b16 v[206:207], v9 offset:3584
    s_cmp_eq_u32 s39, 0
    s_cbranch_scc0 standalone__mha_block__prompt_kernel_fdb
    s_mov_b64 exec, 0xff
    global_store_dwordx2 v235, v[240:241], s[46:47] sc0 sc1
    s_branch standalone__mha_block__prompt_kernel_feb
standalone__mha_block__prompt_kernel_fdb:
    s_mov_b64 exec, 0xffff
    global_load_dwordx2 v[16:17], v234, s[46:47] sc1
standalone__mha_block__prompt_kernel_feb:
    s_mov_b64 exec, -1
    s_add_u32 s34, s36, 6144
    buffer_load_dwordx4 v[88:91], v12, s[16:19], s34 offen offset:0 sc1
    ds_read_b64_tr_b16 v[208:209], v9 offset:4096
    ds_read_b64_tr_b16 v[210:211], v9 offset:5120
    ds_read_b64_tr_b16 v[212:213], v9 offset:4608
    ds_read_b64_tr_b16 v[214:215], v9 offset:5632
    s_waitcnt vmcnt(7) lgkmcnt(8)
    v_mfma_f32_32x32x16_bf16 v[32:47], v[192:195], v[64:67], 0
    v_mfma_f32_32x32x16_bf16 v[48:63], v[196:199], v[64:67], 0
    s_add_u32 s34, s36, 6144
    buffer_load_dwordx4 v[92:95], v12, s[16:19], s34 offen offset:1024 sc1
    ds_read_b64_tr_b16 v[216:217], v9 offset:6144
    ds_read_b64_tr_b16 v[218:219], v9 offset:7168
    ds_read_b64_tr_b16 v[220:221], v9 offset:6656
    ds_read_b64_tr_b16 v[222:223], v9 offset:7680
    s_waitcnt vmcnt(7) lgkmcnt(8)
    v_mfma_f32_32x32x16_bf16 v[32:47], v[200:203], v[68:71], v[32:47]
    v_mfma_f32_32x32x16_bf16 v[48:63], v[204:207], v[68:71], v[48:63]
    s_add_u32 s34, s36, 8192
    buffer_load_dwordx4 v[96:99], v12, s[16:19], s34 offen offset:0 sc1
    ds_read_b64_tr_b16 v[192:193], v9 offset:8192
    ds_read_b64_tr_b16 v[194:195], v9 offset:9216
    ds_read_b64_tr_b16 v[196:197], v9 offset:8704
    ds_read_b64_tr_b16 v[198:199], v9 offset:9728
    s_waitcnt vmcnt(7) lgkmcnt(8)
    v_mfma_f32_32x32x16_bf16 v[32:47], v[208:211], v[72:75], v[32:47]
    v_mfma_f32_32x32x16_bf16 v[48:63], v[212:215], v[72:75], v[48:63]
    s_add_u32 s34, s36, 8192
    buffer_load_dwordx4 v[100:103], v12, s[16:19], s34 offen offset:1024 sc1
    ds_read_b64_tr_b16 v[200:201], v9 offset:10240
    ds_read_b64_tr_b16 v[202:203], v9 offset:11264
    ds_read_b64_tr_b16 v[204:205], v9 offset:10752
    ds_read_b64_tr_b16 v[206:207], v9 offset:11776
    s_waitcnt vmcnt(7) lgkmcnt(8)
    v_mfma_f32_32x32x16_bf16 v[32:47], v[216:219], v[76:79], v[32:47]
    v_mfma_f32_32x32x16_bf16 v[48:63], v[220:223], v[76:79], v[48:63]
    s_add_u32 s34, s36, 10240
    buffer_load_dwordx4 v[104:107], v12, s[16:19], s34 offen offset:0 sc1
    ds_read_b64_tr_b16 v[208:209], v9 offset:12288
    ds_read_b64_tr_b16 v[210:211], v9 offset:13312
    ds_read_b64_tr_b16 v[212:213], v9 offset:12800
    ds_read_b64_tr_b16 v[214:215], v9 offset:13824
    s_waitcnt vmcnt(7) lgkmcnt(8)
    v_mfma_f32_32x32x16_bf16 v[32:47], v[192:195], v[80:83], v[32:47]
    v_mfma_f32_32x32x16_bf16 v[48:63], v[196:199], v[80:83], v[48:63]
    s_add_u32 s34, s36, 10240
    buffer_load_dwordx4 v[108:111], v12, s[16:19], s34 offen offset:1024 sc1
    ds_read_b64_tr_b16 v[216:217], v9 offset:14336
    ds_read_b64_tr_b16 v[218:219], v9 offset:15360
    ds_read_b64_tr_b16 v[220:221], v9 offset:14848
    ds_read_b64_tr_b16 v[222:223], v9 offset:15872
    s_waitcnt vmcnt(7) lgkmcnt(8)
    v_mfma_f32_32x32x16_bf16 v[32:47], v[200:203], v[84:87], v[32:47]
    v_mfma_f32_32x32x16_bf16 v[48:63], v[204:207], v[84:87], v[48:63]
    s_add_u32 s34, s36, 12288
    buffer_load_dwordx4 v[112:115], v12, s[16:19], s34 offen offset:0 sc1
    ds_read_b64_tr_b16 v[192:193], v9 offset:16384
    ds_read_b64_tr_b16 v[194:195], v9 offset:17408
    ds_read_b64_tr_b16 v[196:197], v9 offset:16896
    ds_read_b64_tr_b16 v[198:199], v9 offset:17920
    s_waitcnt vmcnt(6) lgkmcnt(8)
    v_mfma_f32_32x32x16_bf16 v[32:47], v[208:211], v[88:91], v[32:47]
    v_mfma_f32_32x32x16_bf16 v[48:63], v[212:215], v[88:91], v[48:63]
    s_add_u32 s34, s36, 12288
    buffer_load_dwordx4 v[116:119], v12, s[16:19], s34 offen offset:1024 sc1
    ds_read_b64_tr_b16 v[200:201], v9 offset:18432
    ds_read_b64_tr_b16 v[202:203], v9 offset:19456
    ds_read_b64_tr_b16 v[204:205], v9 offset:18944
    ds_read_b64_tr_b16 v[206:207], v9 offset:19968
    s_waitcnt vmcnt(6) lgkmcnt(8)
    v_mfma_f32_32x32x16_bf16 v[32:47], v[216:219], v[92:95], v[32:47]
    v_mfma_f32_32x32x16_bf16 v[48:63], v[220:223], v[92:95], v[48:63]
    s_add_u32 s34, s36, 14336
    buffer_load_dwordx4 v[120:123], v12, s[16:19], s34 offen offset:0 sc1
    ds_read_b64_tr_b16 v[208:209], v9 offset:20480
    ds_read_b64_tr_b16 v[210:211], v9 offset:21504
    ds_read_b64_tr_b16 v[212:213], v9 offset:20992
    ds_read_b64_tr_b16 v[214:215], v9 offset:22016
    s_waitcnt vmcnt(6) lgkmcnt(8)
    v_mfma_f32_32x32x16_bf16 v[32:47], v[192:195], v[96:99], v[32:47]
    v_mfma_f32_32x32x16_bf16 v[48:63], v[196:199], v[96:99], v[48:63]
    s_add_u32 s34, s36, 14336
    buffer_load_dwordx4 v[124:127], v12, s[16:19], s34 offen offset:1024 sc1
    ds_read_b64_tr_b16 v[216:217], v9 offset:22528
    ds_read_b64_tr_b16 v[218:219], v9 offset:23552
    ds_read_b64_tr_b16 v[220:221], v9 offset:23040
    ds_read_b64_tr_b16 v[222:223], v9 offset:24064
    s_waitcnt vmcnt(6) lgkmcnt(8)
    v_mfma_f32_32x32x16_bf16 v[32:47], v[200:203], v[100:103], v[32:47]
    v_mfma_f32_32x32x16_bf16 v[48:63], v[204:207], v[100:103], v[48:63]
    s_add_u32 s34, s37, 0
    buffer_load_dwordx4 v[128:131], v12, s[16:19], s34 offen offset:0 sc1
    ds_read_b64_tr_b16 v[192:193], v9 offset:24576
    ds_read_b64_tr_b16 v[194:195], v9 offset:25600
    ds_read_b64_tr_b16 v[196:197], v9 offset:25088
    ds_read_b64_tr_b16 v[198:199], v9 offset:26112
    s_waitcnt vmcnt(6) lgkmcnt(8)
    v_mfma_f32_32x32x16_bf16 v[32:47], v[208:211], v[104:107], v[32:47]
    v_mfma_f32_32x32x16_bf16 v[48:63], v[212:215], v[104:107], v[48:63]
    s_add_u32 s34, s37, 0
    buffer_load_dwordx4 v[132:135], v12, s[16:19], s34 offen offset:1024 sc1
    ds_read_b64_tr_b16 v[200:201], v9 offset:26624
    ds_read_b64_tr_b16 v[202:203], v9 offset:27648
    ds_read_b64_tr_b16 v[204:205], v9 offset:27136
    ds_read_b64_tr_b16 v[206:207], v9 offset:28160
    s_waitcnt vmcnt(6) lgkmcnt(8)
    v_mfma_f32_32x32x16_bf16 v[32:47], v[216:219], v[108:111], v[32:47]
    v_mfma_f32_32x32x16_bf16 v[48:63], v[220:223], v[108:111], v[48:63]
    s_add_u32 s34, s37, 2048
    buffer_load_dwordx4 v[136:139], v12, s[16:19], s34 offen offset:0 sc1
    ds_read_b64_tr_b16 v[208:209], v9 offset:28672
    ds_read_b64_tr_b16 v[210:211], v9 offset:29696
    ds_read_b64_tr_b16 v[212:213], v9 offset:29184
    ds_read_b64_tr_b16 v[214:215], v9 offset:30208
    s_waitcnt vmcnt(6) lgkmcnt(8)
    v_mfma_f32_32x32x16_bf16 v[32:47], v[192:195], v[112:115], v[32:47]
    v_mfma_f32_32x32x16_bf16 v[48:63], v[196:199], v[112:115], v[48:63]
    s_add_u32 s34, s37, 2048
    buffer_load_dwordx4 v[140:143], v12, s[16:19], s34 offen offset:1024 sc1
    ds_read_b64_tr_b16 v[216:217], v9 offset:30720
    ds_read_b64_tr_b16 v[218:219], v9 offset:31744
    ds_read_b64_tr_b16 v[220:221], v9 offset:31232
    ds_read_b64_tr_b16 v[222:223], v9 offset:32256
    s_waitcnt vmcnt(6) lgkmcnt(8)
    v_mfma_f32_32x32x16_bf16 v[32:47], v[200:203], v[116:119], v[32:47]
    v_mfma_f32_32x32x16_bf16 v[48:63], v[204:207], v[116:119], v[48:63]
    s_add_u32 s34, s37, 4096
    buffer_load_dwordx4 v[144:147], v12, s[16:19], s34 offen offset:0 sc1
    ds_read_b64_tr_b16 v[192:193], v10 offset:0
    ds_read_b64_tr_b16 v[194:195], v10 offset:1024
    ds_read_b64_tr_b16 v[196:197], v10 offset:512
    ds_read_b64_tr_b16 v[198:199], v10 offset:1536
    s_waitcnt vmcnt(6) lgkmcnt(8)
    v_mfma_f32_32x32x16_bf16 v[32:47], v[208:211], v[120:123], v[32:47]
    v_mfma_f32_32x32x16_bf16 v[48:63], v[212:215], v[120:123], v[48:63]
    s_add_u32 s34, s37, 4096
    buffer_load_dwordx4 v[148:151], v12, s[16:19], s34 offen offset:1024 sc1
    ds_read_b64_tr_b16 v[200:201], v10 offset:2048
    ds_read_b64_tr_b16 v[202:203], v10 offset:3072
    ds_read_b64_tr_b16 v[204:205], v10 offset:2560
    ds_read_b64_tr_b16 v[206:207], v10 offset:3584
    s_waitcnt vmcnt(6) lgkmcnt(8)
    v_mfma_f32_32x32x16_bf16 v[32:47], v[216:219], v[124:127], v[32:47]
    v_mfma_f32_32x32x16_bf16 v[48:63], v[220:223], v[124:127], v[48:63]
    s_add_u32 s34, s37, 6144
    buffer_load_dwordx4 v[152:155], v12, s[16:19], s34 offen offset:0 sc1
    ds_read_b64_tr_b16 v[208:209], v10 offset:4096
    ds_read_b64_tr_b16 v[210:211], v10 offset:5120
    ds_read_b64_tr_b16 v[212:213], v10 offset:4608
    ds_read_b64_tr_b16 v[214:215], v10 offset:5632
    s_waitcnt vmcnt(6) lgkmcnt(8)
    v_mfma_f32_32x32x16_bf16 v[32:47], v[192:195], v[128:131], v[32:47]
    v_mfma_f32_32x32x16_bf16 v[48:63], v[196:199], v[128:131], v[48:63]
    s_add_u32 s34, s37, 6144
    buffer_load_dwordx4 v[156:159], v12, s[16:19], s34 offen offset:1024 sc1
    ds_read_b64_tr_b16 v[216:217], v10 offset:6144
    ds_read_b64_tr_b16 v[218:219], v10 offset:7168
    ds_read_b64_tr_b16 v[220:221], v10 offset:6656
    ds_read_b64_tr_b16 v[222:223], v10 offset:7680
    s_waitcnt vmcnt(6) lgkmcnt(8)
    v_mfma_f32_32x32x16_bf16 v[32:47], v[200:203], v[132:135], v[32:47]
    v_mfma_f32_32x32x16_bf16 v[48:63], v[204:207], v[132:135], v[48:63]
    s_add_u32 s34, s37, 8192
    buffer_load_dwordx4 v[160:163], v12, s[16:19], s34 offen offset:0 sc1
    ds_read_b64_tr_b16 v[192:193], v10 offset:8192
    ds_read_b64_tr_b16 v[194:195], v10 offset:9216
    ds_read_b64_tr_b16 v[196:197], v10 offset:8704
    ds_read_b64_tr_b16 v[198:199], v10 offset:9728
    s_waitcnt vmcnt(6) lgkmcnt(8)
    v_mfma_f32_32x32x16_bf16 v[32:47], v[208:211], v[136:139], v[32:47]
    v_mfma_f32_32x32x16_bf16 v[48:63], v[212:215], v[136:139], v[48:63]
    s_add_u32 s34, s37, 8192
    buffer_load_dwordx4 v[164:167], v12, s[16:19], s34 offen offset:1024 sc1
    ds_read_b64_tr_b16 v[200:201], v10 offset:10240
    ds_read_b64_tr_b16 v[202:203], v10 offset:11264
    ds_read_b64_tr_b16 v[204:205], v10 offset:10752
    ds_read_b64_tr_b16 v[206:207], v10 offset:11776
    s_waitcnt vmcnt(6) lgkmcnt(8)
    v_mfma_f32_32x32x16_bf16 v[32:47], v[216:219], v[140:143], v[32:47]
    v_mfma_f32_32x32x16_bf16 v[48:63], v[220:223], v[140:143], v[48:63]
    s_add_u32 s34, s37, 10240
    buffer_load_dwordx4 v[168:171], v12, s[16:19], s34 offen offset:0 sc1
    ds_read_b64_tr_b16 v[208:209], v10 offset:12288
    ds_read_b64_tr_b16 v[210:211], v10 offset:13312
    ds_read_b64_tr_b16 v[212:213], v10 offset:12800
    ds_read_b64_tr_b16 v[214:215], v10 offset:13824
    s_waitcnt vmcnt(6) lgkmcnt(8)
    v_mfma_f32_32x32x16_bf16 v[32:47], v[192:195], v[144:147], v[32:47]
    v_mfma_f32_32x32x16_bf16 v[48:63], v[196:199], v[144:147], v[48:63]
    s_add_u32 s34, s37, 10240
    buffer_load_dwordx4 v[172:175], v12, s[16:19], s34 offen offset:1024 sc1
    ds_read_b64_tr_b16 v[216:217], v10 offset:14336
    ds_read_b64_tr_b16 v[218:219], v10 offset:15360
    ds_read_b64_tr_b16 v[220:221], v10 offset:14848
    ds_read_b64_tr_b16 v[222:223], v10 offset:15872
    s_waitcnt vmcnt(6) lgkmcnt(8)
    v_mfma_f32_32x32x16_bf16 v[32:47], v[200:203], v[148:151], v[32:47]
    v_mfma_f32_32x32x16_bf16 v[48:63], v[204:207], v[148:151], v[48:63]
    s_add_u32 s34, s37, 12288
    buffer_load_dwordx4 v[176:179], v12, s[16:19], s34 offen offset:0 sc1
    ds_read_b64_tr_b16 v[192:193], v10 offset:16384
    ds_read_b64_tr_b16 v[194:195], v10 offset:17408
    ds_read_b64_tr_b16 v[196:197], v10 offset:16896
    ds_read_b64_tr_b16 v[198:199], v10 offset:17920
    s_waitcnt vmcnt(6) lgkmcnt(8)
    v_mfma_f32_32x32x16_bf16 v[32:47], v[208:211], v[152:155], v[32:47]
    v_mfma_f32_32x32x16_bf16 v[48:63], v[212:215], v[152:155], v[48:63]
    s_add_u32 s34, s37, 12288
    buffer_load_dwordx4 v[180:183], v12, s[16:19], s34 offen offset:1024 sc1
    ds_read_b64_tr_b16 v[200:201], v10 offset:18432
    ds_read_b64_tr_b16 v[202:203], v10 offset:19456
    ds_read_b64_tr_b16 v[204:205], v10 offset:18944
    ds_read_b64_tr_b16 v[206:207], v10 offset:19968
    s_waitcnt vmcnt(6) lgkmcnt(8)
    v_mfma_f32_32x32x16_bf16 v[32:47], v[216:219], v[156:159], v[32:47]
    v_mfma_f32_32x32x16_bf16 v[48:63], v[220:223], v[156:159], v[48:63]
    s_add_u32 s34, s37, 14336
    buffer_load_dwordx4 v[184:187], v12, s[16:19], s34 offen offset:0 sc1
    ds_read_b64_tr_b16 v[208:209], v10 offset:20480
    ds_read_b64_tr_b16 v[210:211], v10 offset:21504
    ds_read_b64_tr_b16 v[212:213], v10 offset:20992
    ds_read_b64_tr_b16 v[214:215], v10 offset:22016
    s_waitcnt vmcnt(6) lgkmcnt(8)
    v_mfma_f32_32x32x16_bf16 v[32:47], v[192:195], v[160:163], v[32:47]
    v_mfma_f32_32x32x16_bf16 v[48:63], v[196:199], v[160:163], v[48:63]
    s_add_u32 s34, s37, 14336
    buffer_load_dwordx4 v[188:191], v12, s[16:19], s34 offen offset:1024 sc1
    ds_read_b64_tr_b16 v[216:217], v10 offset:22528
    ds_read_b64_tr_b16 v[218:219], v10 offset:23552
    ds_read_b64_tr_b16 v[220:221], v10 offset:23040
    ds_read_b64_tr_b16 v[222:223], v10 offset:24064
    s_waitcnt vmcnt(6) lgkmcnt(8)
    v_mfma_f32_32x32x16_bf16 v[32:47], v[200:203], v[164:167], v[32:47]
    v_mfma_f32_32x32x16_bf16 v[48:63], v[204:207], v[164:167], v[48:63]
    ds_read_b64_tr_b16 v[192:193], v10 offset:24576
    ds_read_b64_tr_b16 v[194:195], v10 offset:25600
    ds_read_b64_tr_b16 v[196:197], v10 offset:25088
    ds_read_b64_tr_b16 v[198:199], v10 offset:26112
    s_waitcnt vmcnt(5) lgkmcnt(8)
    v_mfma_f32_32x32x16_bf16 v[32:47], v[208:211], v[168:171], v[32:47]
    v_mfma_f32_32x32x16_bf16 v[48:63], v[212:215], v[168:171], v[48:63]
    ds_read_b64_tr_b16 v[200:201], v10 offset:26624
    ds_read_b64_tr_b16 v[202:203], v10 offset:27648
    ds_read_b64_tr_b16 v[204:205], v10 offset:27136
    ds_read_b64_tr_b16 v[206:207], v10 offset:28160
    s_waitcnt vmcnt(4) lgkmcnt(8)
    v_mfma_f32_32x32x16_bf16 v[32:47], v[216:219], v[172:175], v[32:47]
    v_mfma_f32_32x32x16_bf16 v[48:63], v[220:223], v[172:175], v[48:63]
    ds_read_b64_tr_b16 v[208:209], v10 offset:28672
    ds_read_b64_tr_b16 v[210:211], v10 offset:29696
    ds_read_b64_tr_b16 v[212:213], v10 offset:29184
    ds_read_b64_tr_b16 v[214:215], v10 offset:30208
    s_waitcnt vmcnt(3) lgkmcnt(8)
    v_mfma_f32_32x32x16_bf16 v[32:47], v[192:195], v[176:179], v[32:47]
    v_mfma_f32_32x32x16_bf16 v[48:63], v[196:199], v[176:179], v[48:63]
    ds_read_b64_tr_b16 v[216:217], v10 offset:30720
    ds_read_b64_tr_b16 v[218:219], v10 offset:31744
    ds_read_b64_tr_b16 v[220:221], v10 offset:31232
    ds_read_b64_tr_b16 v[222:223], v10 offset:32256
    s_waitcnt vmcnt(2) lgkmcnt(8)
    v_mfma_f32_32x32x16_bf16 v[32:47], v[200:203], v[180:183], v[32:47]
    v_mfma_f32_32x32x16_bf16 v[48:63], v[204:207], v[180:183], v[48:63]
    s_waitcnt vmcnt(1) lgkmcnt(4)
    v_mfma_f32_32x32x16_bf16 v[32:47], v[208:211], v[184:187], v[32:47]
    v_mfma_f32_32x32x16_bf16 v[48:63], v[212:215], v[184:187], v[48:63]
    s_waitcnt vmcnt(0) lgkmcnt(0)
    v_mfma_f32_32x32x16_bf16 v[32:47], v[216:219], v[188:191], v[32:47]
    v_mfma_f32_32x32x16_bf16 v[48:63], v[220:223], v[188:191], v[48:63]
    s_branch standalone__mha_block__prompt_kernel_p3e
standalone__mha_block__prompt_kernel_split:
    s_add_u32 s34, s36, 0
    buffer_load_dwordx4 v[64:67], v12, s[16:19], s34 offen offset:0 sc1
    s_add_u32 s34, s36, 0
    buffer_load_dwordx4 v[68:71], v12, s[16:19], s34 offen offset:1024 sc1
    s_add_u32 s34, s36, 2048
    buffer_load_dwordx4 v[72:75], v12, s[16:19], s34 offen offset:0 sc1
    s_add_u32 s34, s36, 2048
    buffer_load_dwordx4 v[76:79], v12, s[16:19], s34 offen offset:1024 sc1
    s_add_u32 s34, s36, 4096
    buffer_load_dwordx4 v[80:83], v12, s[16:19], s34 offen offset:0 sc1
    s_add_u32 s34, s36, 4096
    buffer_load_dwordx4 v[84:87], v12, s[16:19], s34 offen offset:1024 sc1
    v_lshrrev_b32 v4, 5, v2
    v_lshlrev_b32 v4, 8, v4
    v_and_b32 v5, 15, v2
    v_lshrrev_b32 v7, 2, v5
    v_lshlrev_b32 v7, 6, v7
    v_add_u32 v4, v4, v7
    v_and_b32 v7, 3, v5
    v_lshlrev_b32 v7, 3, v7
    v_add_u32 v4, v4, v7
    v_lshrrev_b32 v7, 4, v2
    v_and_b32 v7, 1, v7
    v_lshlrev_b32 v7, 5, v7
    v_add_u32 v4, v4, v7
    s_lshl_b32 s61, s28, 17
    s_lshl_b32 s62, s28, 16
    s_add_u32 s62, s62, 32768
    s_cmp_eq_u32 s38, 0xff00
    s_cselect_b32 s63, s61, s62
    s_cselect_b32 s62, s62, s61
    v_add_u32 v9, s63, v4
    v_add_u32 v10, s62, v4
    s_xor_b32 s61, s24, 4
    s_lshl_b32 s61, s61, 12
    s_add_u32 s61, s61, 65536
    v_lshrrev_b32 v24, 2, v2
    s_lshl_b32 s62, s27, 5
    v_lshlrev_b32 v25, 6, v24
    v_add_u32 v24, s62, v24
    v_lshlrev_b32 v24, 11, v24
    v_and_b32 v26, 3, v2
    v_lshlrev_b32 v27, 4, v26
    v_add_u32 v24, v24, v27
    v_bfe_u32 v27, v2, 3, 2
    v_xor_b32 v26, v26, v27
    v_lshlrev_b32 v26, 4, v26
    v_add3_u32 v25, v25, v26, s61
    v_and_b32 v26, 31, v2
    v_lshlrev_b32 v26, 6, v26
    v_bfe_u32 v27, v2, 1, 2
    v_lshrrev_b32 v28, 5, v2
    v_xor_b32 v27, v27, v28
    v_lshlrev_b32 v27, 4, v27
    v_add3_u32 v26, v26, v27, s61
    v_xor_b32 v27, 32, v26
    s_lshl_b32 s30, s0, 18
    s_add_u32 s30, s30, s29
    s_lshl_b32 s61, s28, 6
    s_add_u32 s30, s30, s61
    s_add_u32 s31, s30, 32768
    s_mov_b32 s20, s10
    s_mov_b32 s21, s11
    s_mov_b32 s22, 4194304
    s_mov_b32 s23, 0x20000
    s_cmp_lg_u32 s43, 0
    s_cbranch_scc1 standalone__mha_block__prompt_kernel_nbs
    s_waitcnt vmcnt(6)
    s_barrier
standalone__mha_block__prompt_kernel_nbs:
    ds_read_b64_tr_b16 v[192:193], v9 offset:0
    ds_read_b64_tr_b16 v[194:195], v9 offset:1024
    ds_read_b64_tr_b16 v[196:197], v9 offset:512
    ds_read_b64_tr_b16 v[198:199], v9 offset:1536
    ds_read_b64_tr_b16 v[200:201], v9 offset:2048
    ds_read_b64_tr_b16 v[202:203], v9 offset:3072
    ds_read_b64_tr_b16 v[204:205], v9 offset:2560
    ds_read_b64_tr_b16 v[206:207], v9 offset:3584
    s_cmp_eq_u32 s39, 0
    s_cbranch_scc0 standalone__mha_block__prompt_kernel_fds
    s_mov_b64 exec, 0xff
    global_store_dwordx2 v235, v[240:241], s[46:47] sc0 sc1
    s_branch standalone__mha_block__prompt_kernel_fes
standalone__mha_block__prompt_kernel_fds:
    s_mov_b64 exec, 0xffff
    global_load_dwordx2 v[16:17], v234, s[46:47] sc1
standalone__mha_block__prompt_kernel_fes:
    s_mov_b64 exec, 0xffff
    global_load_dwordx2 v[14:15], v234, s[46:47] sc1
    s_mov_b64 exec, -1
    s_add_u32 s34, s36, 6144
    buffer_load_dwordx4 v[88:91], v12, s[16:19], s34 offen offset:0 sc1
    ds_read_b64_tr_b16 v[208:209], v9 offset:4096
    ds_read_b64_tr_b16 v[210:211], v9 offset:5120
    ds_read_b64_tr_b16 v[212:213], v9 offset:4608
    ds_read_b64_tr_b16 v[214:215], v9 offset:5632
    s_waitcnt vmcnt(8) lgkmcnt(8)
    v_mfma_f32_32x32x16_bf16 v[32:47], v[192:195], v[64:67], 0
    v_mfma_f32_32x32x16_bf16 v[48:63], v[196:199], v[64:67], 0
    s_add_u32 s34, s36, 6144
    buffer_load_dwordx4 v[92:95], v12, s[16:19], s34 offen offset:1024 sc1
    ds_read_b64_tr_b16 v[216:217], v9 offset:6144
    ds_read_b64_tr_b16 v[218:219], v9 offset:7168
    ds_read_b64_tr_b16 v[220:221], v9 offset:6656
    ds_read_b64_tr_b16 v[222:223], v9 offset:7680
    s_waitcnt vmcnt(8) lgkmcnt(8)
    v_mfma_f32_32x32x16_bf16 v[32:47], v[200:203], v[68:71], v[32:47]
    v_mfma_f32_32x32x16_bf16 v[48:63], v[204:207], v[68:71], v[48:63]
    s_add_u32 s34, s36, 8192
    buffer_load_dwordx4 v[96:99], v12, s[16:19], s34 offen offset:0 sc1
    ds_read_b64_tr_b16 v[192:193], v9 offset:8192
    ds_read_b64_tr_b16 v[194:195], v9 offset:9216
    ds_read_b64_tr_b16 v[196:197], v9 offset:8704
    ds_read_b64_tr_b16 v[198:199], v9 offset:9728
    s_waitcnt vmcnt(8) lgkmcnt(8)
    v_mfma_f32_32x32x16_bf16 v[32:47], v[208:211], v[72:75], v[32:47]
    v_mfma_f32_32x32x16_bf16 v[48:63], v[212:215], v[72:75], v[48:63]
    s_add_u32 s34, s36, 8192
    buffer_load_dwordx4 v[100:103], v12, s[16:19], s34 offen offset:1024 sc1
    ds_read_b64_tr_b16 v[200:201], v9 offset:10240
    ds_read_b64_tr_b16 v[202:203], v9 offset:11264
    ds_read_b64_tr_b16 v[204:205], v9 offset:10752
    ds_read_b64_tr_b16 v[206:207], v9 offset:11776
    s_waitcnt vmcnt(8) lgkmcnt(8)
    v_mfma_f32_32x32x16_bf16 v[32:47], v[216:219], v[76:79], v[32:47]
    v_mfma_f32_32x32x16_bf16 v[48:63], v[220:223], v[76:79], v[48:63]
    s_add_u32 s34, s36, 10240
    buffer_load_dwordx4 v[104:107], v12, s[16:19], s34 offen offset:0 sc1
    ds_read_b64_tr_b16 v[208:209], v9 offset:12288
    ds_read_b64_tr_b16 v[210:211], v9 offset:13312
    ds_read_b64_tr_b16 v[212:213], v9 offset:12800
    ds_read_b64_tr_b16 v[214:215], v9 offset:13824
    s_waitcnt vmcnt(8) lgkmcnt(8)
    v_mfma_f32_32x32x16_bf16 v[32:47], v[192:195], v[80:83], v[32:47]
    v_mfma_f32_32x32x16_bf16 v[48:63], v[196:199], v[80:83], v[48:63]
    s_add_u32 s34, s36, 10240
    buffer_load_dwordx4 v[108:111], v12, s[16:19], s34 offen offset:1024 sc1
    ds_read_b64_tr_b16 v[216:217], v9 offset:14336
    ds_read_b64_tr_b16 v[218:219], v9 offset:15360
    ds_read_b64_tr_b16 v[220:221], v9 offset:14848
    ds_read_b64_tr_b16 v[222:223], v9 offset:15872
    s_waitcnt vmcnt(8) lgkmcnt(8)
    v_mfma_f32_32x32x16_bf16 v[32:47], v[200:203], v[84:87], v[32:47]
    v_mfma_f32_32x32x16_bf16 v[48:63], v[204:207], v[84:87], v[48:63]
    s_add_u32 s34, s36, 12288
    buffer_load_dwordx4 v[112:115], v12, s[16:19], s34 offen offset:0 sc1
    ds_read_b64_tr_b16 v[192:193], v9 offset:16384
    ds_read_b64_tr_b16 v[194:195], v9 offset:17408
    ds_read_b64_tr_b16 v[196:197], v9 offset:16896
    ds_read_b64_tr_b16 v[198:199], v9 offset:17920
    s_waitcnt vmcnt(6) lgkmcnt(8)
    v_mfma_f32_32x32x16_bf16 v[32:47], v[208:211], v[88:91], v[32:47]
    v_mfma_f32_32x32x16_bf16 v[48:63], v[212:215], v[88:91], v[48:63]
    s_add_u32 s34, s36, 12288
    buffer_load_dwordx4 v[116:119], v12, s[16:19], s34 offen offset:1024 sc1
    ds_read_b64_tr_b16 v[200:201], v9 offset:18432
    ds_read_b64_tr_b16 v[202:203], v9 offset:19456
    ds_read_b64_tr_b16 v[204:205], v9 offset:18944
    ds_read_b64_tr_b16 v[206:207], v9 offset:19968
    s_waitcnt vmcnt(6) lgkmcnt(8)
    v_mfma_f32_32x32x16_bf16 v[32:47], v[216:219], v[92:95], v[32:47]
    v_mfma_f32_32x32x16_bf16 v[48:63], v[220:223], v[92:95], v[48:63]
    s_add_u32 s34, s36, 14336
    buffer_load_dwordx4 v[120:123], v12, s[16:19], s34 offen offset:0 sc1
    ds_read_b64_tr_b16 v[208:209], v9 offset:20480
    ds_read_b64_tr_b16 v[210:211], v9 offset:21504
    ds_read_b64_tr_b16 v[212:213], v9 offset:20992
    ds_read_b64_tr_b16 v[214:215], v9 offset:22016
    s_waitcnt vmcnt(6) lgkmcnt(8)
    v_mfma_f32_32x32x16_bf16 v[32:47], v[192:195], v[96:99], v[32:47]
    v_mfma_f32_32x32x16_bf16 v[48:63], v[196:199], v[96:99], v[48:63]
    s_add_u32 s34, s36, 14336
    buffer_load_dwordx4 v[124:127], v12, s[16:19], s34 offen offset:1024 sc1
    ds_read_b64_tr_b16 v[216:217], v9 offset:22528
    ds_read_b64_tr_b16 v[218:219], v9 offset:23552
    ds_read_b64_tr_b16 v[220:221], v9 offset:23040
    ds_read_b64_tr_b16 v[222:223], v9 offset:24064
    s_waitcnt vmcnt(6) lgkmcnt(8)
    v_mfma_f32_32x32x16_bf16 v[32:47], v[200:203], v[100:103], v[32:47]
    v_mfma_f32_32x32x16_bf16 v[48:63], v[204:207], v[100:103], v[48:63]
    ds_read_b64_tr_b16 v[192:193], v9 offset:24576
    ds_read_b64_tr_b16 v[194:195], v9 offset:25600
    ds_read_b64_tr_b16 v[196:197], v9 offset:25088
    ds_read_b64_tr_b16 v[198:199], v9 offset:26112
    s_waitcnt vmcnt(5) lgkmcnt(8)
    v_mfma_f32_32x32x16_bf16 v[32:47], v[208:211], v[104:107], v[32:47]
    v_mfma_f32_32x32x16_bf16 v[48:63], v[212:215], v[104:107], v[48:63]
    ds_read_b64_tr_b16 v[200:201], v9 offset:26624
    ds_read_b64_tr_b16 v[202:203], v9 offset:27648
    ds_read_b64_tr_b16 v[204:205], v9 offset:27136
    ds_read_b64_tr_b16 v[206:207], v9 offset:28160
    s_waitcnt vmcnt(4) lgkmcnt(8)
    v_mfma_f32_32x32x16_bf16 v[32:47], v[216:219], v[108:111], v[32:47]
    v_mfma_f32_32x32x16_bf16 v[48:63], v[220:223], v[108:111], v[48:63]
    ds_read_b64_tr_b16 v[208:209], v9 offset:28672
    ds_read_b64_tr_b16 v[210:211], v9 offset:29696
    ds_read_b64_tr_b16 v[212:213], v9 offset:29184
    ds_read_b64_tr_b16 v[214:215], v9 offset:30208
    s_waitcnt vmcnt(3) lgkmcnt(8)
    v_mfma_f32_32x32x16_bf16 v[32:47], v[192:195], v[112:115], v[32:47]
    v_mfma_f32_32x32x16_bf16 v[48:63], v[196:199], v[112:115], v[48:63]
    ds_read_b64_tr_b16 v[216:217], v9 offset:30720
    ds_read_b64_tr_b16 v[218:219], v9 offset:31744
    ds_read_b64_tr_b16 v[220:221], v9 offset:31232
    ds_read_b64_tr_b16 v[222:223], v9 offset:32256
    s_waitcnt vmcnt(2) lgkmcnt(8)
    v_mfma_f32_32x32x16_bf16 v[32:47], v[200:203], v[116:119], v[32:47]
    v_mfma_f32_32x32x16_bf16 v[48:63], v[204:207], v[116:119], v[48:63]
    ds_read_b64_tr_b16 v[192:193], v10 offset:0
    ds_read_b64_tr_b16 v[194:195], v10 offset:1024
    ds_read_b64_tr_b16 v[196:197], v10 offset:512
    ds_read_b64_tr_b16 v[198:199], v10 offset:1536
    s_waitcnt vmcnt(1) lgkmcnt(8)
    v_mfma_f32_32x32x16_bf16 v[32:47], v[208:211], v[120:123], v[32:47]
    v_mfma_f32_32x32x16_bf16 v[48:63], v[212:215], v[120:123], v[48:63]
    ds_read_b64_tr_b16 v[200:201], v10 offset:2048
    ds_read_b64_tr_b16 v[202:203], v10 offset:3072
    ds_read_b64_tr_b16 v[204:205], v10 offset:2560
    ds_read_b64_tr_b16 v[206:207], v10 offset:3584
    s_waitcnt vmcnt(0) lgkmcnt(8)
    v_mfma_f32_32x32x16_bf16 v[32:47], v[216:219], v[124:127], v[32:47]
    v_mfma_f32_32x32x16_bf16 v[48:63], v[220:223], v[124:127], v[48:63]
    s_waitcnt vmcnt(0)
    s_mov_b64 exec, 0xffff
    s_mov_b32 s63, 0
standalone__mha_block__prompt_kernel_q2:
    v_cmp_ne_u32 vcc, s50, v14
    v_cmp_ne_u32 s[52:53], s51, v15
    s_nop 3
    s_or_b32 s52, vcc_lo, s52
    s_add_u32 s63, s63, 1
    s_and_b32 s61, s52, s38
    s_cbranch_scc0 standalone__mha_block__prompt_kernel_q2x
    s_cmp_ge_u32 s63, 262144
    s_cbranch_scc1 standalone__mha_block__prompt_kernel_q2x
    s_sleep 4
    global_load_dwordx2 v[14:15], v234, s[46:47] sc1
    s_waitcnt vmcnt(0)
    s_branch standalone__mha_block__prompt_kernel_q2
standalone__mha_block__prompt_kernel_q2x:
    s_mov_b64 exec, -1
    s_add_u32 s34, s37, 0
    buffer_load_dwordx4 v[128:131], v12, s[16:19], s34 offen offset:0 sc1
    s_add_u32 s34, s37, 0
    buffer_load_dwordx4 v[132:135], v12, s[16:19], s34 offen offset:1024 sc1
    s_add_u32 s34, s37, 2048
    buffer_load_dwordx4 v[136:139], v12, s[16:19], s34 offen offset:0 sc1
    s_add_u32 s34, s37, 2048
    buffer_load_dwordx4 v[140:143], v12, s[16:19], s34 offen offset:1024 sc1
    s_add_u32 s34, s37, 4096
    buffer_load_dwordx4 v[144:147], v12, s[16:19], s34 offen offset:0 sc1
    s_add_u32 s34, s37, 4096
    buffer_load_dwordx4 v[148:151], v12, s[16:19], s34 offen offset:1024 sc1
    s_add_u32 s34, s37, 6144
    buffer_load_dwordx4 v[152:155], v12, s[16:19], s34 offen offset:0 sc1
    ds_read_b64_tr_b16 v[208:209], v10 offset:4096
    ds_read_b64_tr_b16 v[210:211], v10 offset:5120
    ds_read_b64_tr_b16 v[212:213], v10 offset:4608
    ds_read_b64_tr_b16 v[214:215], v10 offset:5632
    s_waitcnt vmcnt(6) lgkmcnt(8)
    v_mfma_f32_32x32x16_bf16 v[32:47], v[192:195], v[128:131], v[32:47]
    v_mfma_f32_32x32x16_bf16 v[48:63], v[196:199], v[128:131], v[48:63]
    s_add_u32 s34, s37, 6144
    buffer_load_dwordx4 v[156:159], v12, s[16:19], s34 offen offset:1024 sc1
    ds_read_b64_tr_b16 v[216:217], v10 offset:6144
    ds_read_b64_tr_b16 v[218:219], v10 offset:7168
    ds_read_b64_tr_b16 v[220:221], v10 offset:6656
    ds_read_b64_tr_b16 v[222:223], v10 offset:7680
    s_waitcnt vmcnt(6) lgkmcnt(8)
    v_mfma_f32_32x32x16_bf16 v[32:47], v[200:203], v[132:135], v[32:47]
    v_mfma_f32_32x32x16_bf16 v[48:63], v[204:207], v[132:135], v[48:63]
    s_add_u32 s34, s37, 8192
    buffer_load_dwordx4 v[160:163], v12, s[16:19], s34 offen offset:0 sc1
    ds_read_b64_tr_b16 v[192:193], v10 offset:8192
    ds_read_b64_tr_b16 v[194:195], v10 offset:9216
    ds_read_b64_tr_b16 v[196:197], v10 offset:8704
    ds_read_b64_tr_b16 v[198:199], v10 offset:9728
    s_waitcnt vmcnt(6) lgkmcnt(8)
    v_mfma_f32_32x32x16_bf16 v[32:47], v[208:211], v[136:139], v[32:47]
    v_mfma_f32_32x32x16_bf16 v[48:63], v[212:215], v[136:139], v[48:63]
    s_add_u32 s34, s37, 8192
    buffer_load_dwordx4 v[164:167], v12, s[16:19], s34 offen offset:1024 sc1
    ds_read_b64_tr_b16 v[200:201], v10 offset:10240
    ds_read_b64_tr_b16 v[202:203], v10 offset:11264
    ds_read_b64_tr_b16 v[204:205], v10 offset:10752
    ds_read_b64_tr_b16 v[206:207], v10 offset:11776
    s_waitcnt vmcnt(6) lgkmcnt(8)
    v_mfma_f32_32x32x16_bf16 v[32:47], v[216:219], v[140:143], v[32:47]
    v_mfma_f32_32x32x16_bf16 v[48:63], v[220:223], v[140:143], v[48:63]
    s_add_u32 s34, s37, 10240
    buffer_load_dwordx4 v[168:171], v12, s[16:19], s34 offen offset:0 sc1
    ds_read_b64_tr_b16 v[208:209], v10 offset:12288
    ds_read_b64_tr_b16 v[210:211], v10 offset:13312
    ds_read_b64_tr_b16 v[212:213], v10 offset:12800
    ds_read_b64_tr_b16 v[214:215], v10 offset:13824
    s_waitcnt vmcnt(6) lgkmcnt(8)
    v_mfma_f32_32x32x16_bf16 v[32:47], v[192:195], v[144:147], v[32:47]
    v_mfma_f32_32x32x16_bf16 v[48:63], v[196:199], v[144:147], v[48:63]
    s_add_u32 s34, s37, 10240
    buffer_load_dwordx4 v[172:175], v12, s[16:19], s34 offen offset:1024 sc1
    ds_read_b64_tr_b16 v[216:217], v10 offset:14336
    ds_read_b64_tr_b16 v[218:219], v10 offset:15360
    ds_read_b64_tr_b16 v[220:221], v10 offset:14848
    ds_read_b64_tr_b16 v[222:223], v10 offset:15872
    s_waitcnt vmcnt(6) lgkmcnt(8)
    v_mfma_f32_32x32x16_bf16 v[32:47], v[200:203], v[148:151], v[32:47]
    v_mfma_f32_32x32x16_bf16 v[48:63], v[204:207], v[148:151], v[48:63]
    s_add_u32 s34, s37, 12288
    buffer_load_dwordx4 v[176:179], v12, s[16:19], s34 offen offset:0 sc1
    ds_read_b64_tr_b16 v[192:193], v10 offset:16384
    ds_read_b64_tr_b16 v[194:195], v10 offset:17408
    ds_read_b64_tr_b16 v[196:197], v10 offset:16896
    ds_read_b64_tr_b16 v[198:199], v10 offset:17920
    s_waitcnt vmcnt(6) lgkmcnt(8)
    v_mfma_f32_32x32x16_bf16 v[32:47], v[208:211], v[152:155], v[32:47]
    v_mfma_f32_32x32x16_bf16 v[48:63], v[212:215], v[152:155], v[48:63]
    s_add_u32 s34, s37, 12288
    buffer_load_dwordx4 v[180:183], v12, s[16:19], s34 offen offset:1024 sc1
    ds_read_b64_tr_b16 v[200:201], v10 offset:18432
    ds_read_b64_tr_b16 v[202:203], v10 offset:19456
    ds_read_b64_tr_b16 v[204:205], v10 offset:18944
    ds_read_b64_tr_b16 v[206:207], v10 offset:19968
    s_waitcnt vmcnt(6) lgkmcnt(8)
    v_mfma_f32_32x32x16_bf16 v[32:47], v[216:219], v[156:159], v[32:47]
    v_mfma_f32_32x32x16_bf16 v[48:63], v[220:223], v[156:159], v[48:63]
    s_add_u32 s34, s37, 14336
    buffer_load_dwordx4 v[184:187], v12, s[16:19], s34 offen offset:0 sc1
    ds_read_b64_tr_b16 v[208:209], v10 offset:20480
    ds_read_b64_tr_b16 v[210:211], v10 offset:21504
    ds_read_b64_tr_b16 v[212:213], v10 offset:20992
    ds_read_b64_tr_b16 v[214:215], v10 offset:22016
    s_waitcnt vmcnt(6) lgkmcnt(8)
    v_mfma_f32_32x32x16_bf16 v[32:47], v[192:195], v[160:163], v[32:47]
    v_mfma_f32_32x32x16_bf16 v[48:63], v[196:199], v[160:163], v[48:63]
    s_add_u32 s34, s37, 14336
    buffer_load_dwordx4 v[188:191], v12, s[16:19], s34 offen offset:1024 sc1
    ds_read_b64_tr_b16 v[216:217], v10 offset:22528
    ds_read_b64_tr_b16 v[218:219], v10 offset:23552
    ds_read_b64_tr_b16 v[220:221], v10 offset:23040
    ds_read_b64_tr_b16 v[222:223], v10 offset:24064
    s_waitcnt vmcnt(6) lgkmcnt(8)
    v_mfma_f32_32x32x16_bf16 v[32:47], v[200:203], v[164:167], v[32:47]
    v_mfma_f32_32x32x16_bf16 v[48:63], v[204:207], v[164:167], v[48:63]
    ds_read_b64_tr_b16 v[192:193], v10 offset:24576
    ds_read_b64_tr_b16 v[194:195], v10 offset:25600
    ds_read_b64_tr_b16 v[196:197], v10 offset:25088
    ds_read_b64_tr_b16 v[198:199], v10 offset:26112
    s_waitcnt vmcnt(5) lgkmcnt(8)
    v_mfma_f32_32x32x16_bf16 v[32:47], v[208:211], v[168:171], v[32:47]
    v_mfma_f32_32x32x16_bf16 v[48:63], v[212:215], v[168:171], v[48:63]
    ds_read_b64_tr_b16 v[200:201], v10 offset:26624
    ds_read_b64_tr_b16 v[202:203], v10 offset:27648
    ds_read_b64_tr_b16 v[204:205], v10 offset:27136
    ds_read_b64_tr_b16 v[206:207], v10 offset:28160
    s_waitcnt vmcnt(4) lgkmcnt(8)
    v_mfma_f32_32x32x16_bf16 v[32:47], v[216:219], v[172:175], v[32:47]
    v_mfma_f32_32x32x16_bf16 v[48:63], v[220:223], v[172:175], v[48:63]
    ds_read_b64_tr_b16 v[208:209], v10 offset:28672
    ds_read_b64_tr_b16 v[210:211], v10 offset:29696
    ds_read_b64_tr_b16 v[212:213], v10 offset:29184
    ds_read_b64_tr_b16 v[214:215], v10 offset:30208
    s_waitcnt vmcnt(3) lgkmcnt(8)
    v_mfma_f32_32x32x16_bf16 v[32:47], v[192:195], v[176:179], v[32:47]
    v_mfma_f32_32x32x16_bf16 v[48:63], v[196:199], v[176:179], v[48:63]
    ds_read_b64_tr_b16 v[216:217], v10 offset:30720
    ds_read_b64_tr_b16 v[218:219], v10 offset:31744
    ds_read_b64_tr_b16 v[220:221], v10 offset:31232
    ds_read_b64_tr_b16 v[222:223], v10 offset:32256
    s_waitcnt vmcnt(2) lgkmcnt(8)
    v_mfma_f32_32x32x16_bf16 v[32:47], v[200:203], v[180:183], v[32:47]
    v_mfma_f32_32x32x16_bf16 v[48:63], v[204:207], v[180:183], v[48:63]
    s_waitcnt vmcnt(1) lgkmcnt(4)
    v_mfma_f32_32x32x16_bf16 v[32:47], v[208:211], v[184:187], v[32:47]
    v_mfma_f32_32x32x16_bf16 v[48:63], v[212:215], v[184:187], v[48:63]
    s_waitcnt vmcnt(0) lgkmcnt(0)
    v_mfma_f32_32x32x16_bf16 v[32:47], v[216:219], v[188:191], v[32:47]
    v_mfma_f32_32x32x16_bf16 v[48:63], v[220:223], v[188:191], v[48:63]
standalone__mha_block__prompt_kernel_p3e:
    s_cmp_eq_u32 s28, 0
    s_cbranch_scc1 standalone__mha_block__prompt_kernel_e0
    s_nop 8
    ds_write_b128 v232, v[32:35] offset:0
    ds_write_b128 v232, v[36:39] offset:1024
    ds_write_b128 v232, v[40:43] offset:2048
    ds_write_b128 v232, v[44:47] offset:3072
    s_waitcnt lgkmcnt(0)
    s_barrier
    ds_read_b128 v[64:67], v233 offset:0
    ds_read_b128 v[68:71], v233 offset:1024
    ds_read_b128 v[72:75], v233 offset:2048
    ds_read_b128 v[76:79], v233 offset:3072
    s_waitcnt lgkmcnt(3)
    v_add_f32 v48, v48, v64
    v_add_f32 v49, v49, v65
    v_add_f32 v50, v50, v66
    v_add_f32 v51, v51, v67
    s_waitcnt lgkmcnt(2)
    v_add_f32 v52, v52, v68
    v_add_f32 v53, v53, v69
    v_add_f32 v54, v54, v70
    v_add_f32 v55, v55, v71
    s_waitcnt lgkmcnt(1)
    v_add_f32 v56, v56, v72
    v_add_f32 v57, v57, v73
    v_add_f32 v58, v58, v74
    v_add_f32 v59, v59, v75
    s_waitcnt lgkmcnt(0)
    v_add_f32 v60, v60, v76
    v_add_f32 v61, v61, v77
    v_add_f32 v62, v62, v78
    v_add_f32 v63, v63, v79
    v_cvt_pk_bf16_f32 v96, v48, v49
    v_cvt_pk_bf16_f32 v97, v50, v51
    v_cvt_pk_bf16_f32 v98, v52, v53
    v_cvt_pk_bf16_f32 v99, v54, v55
    v_cvt_pk_bf16_f32 v100, v56, v57
    v_cvt_pk_bf16_f32 v101, v58, v59
    v_cvt_pk_bf16_f32 v102, v60, v61
    v_cvt_pk_bf16_f32 v103, v62, v63
    s_nop 1
    v_permlane32_swap_b32 v96, v98
    v_permlane32_swap_b32 v97, v99
    v_permlane32_swap_b32 v100, v102
    v_permlane32_swap_b32 v101, v103
    s_nop 1
    ds_write_b128 v26, v[96:99]
    ds_write_b128 v27, v[100:103]
    ds_read_b128 v[104:107], v25
    ds_read_b128 v[108:111], v25 offset:1024
    s_waitcnt lgkmcnt(1)
    buffer_store_dwordx4 v[104:107], v24, s[20:23], s30 offen sc0 sc1
    s_waitcnt lgkmcnt(0)
    buffer_store_dwordx4 v[108:111], v24, s[20:23], s31 offen sc0 sc1
    s_endpgm
standalone__mha_block__prompt_kernel_e0:
    s_nop 9
    ds_write_b128 v232, v[48:51] offset:0
    ds_write_b128 v232, v[52:55] offset:1024
    ds_write_b128 v232, v[56:59] offset:2048
    ds_write_b128 v232, v[60:63] offset:3072
    s_waitcnt lgkmcnt(0)
    s_barrier
    ds_read_b128 v[64:67], v233 offset:0
    ds_read_b128 v[68:71], v233 offset:1024
    ds_read_b128 v[72:75], v233 offset:2048
    ds_read_b128 v[76:79], v233 offset:3072
    s_waitcnt lgkmcnt(3)
    v_add_f32 v32, v32, v64
    v_add_f32 v33, v33, v65
    v_add_f32 v34, v34, v66
    v_add_f32 v35, v35, v67
    s_waitcnt lgkmcnt(2)
    v_add_f32 v36, v36, v68
    v_add_f32 v37, v37, v69
    v_add_f32 v38, v38, v70
    v_add_f32 v39, v39, v71
    s_waitcnt lgkmcnt(1)
    v_add_f32 v40, v40, v72
    v_add_f32 v41, v41, v73
    v_add_f32 v42, v42, v74
    v_add_f32 v43, v43, v75
    s_waitcnt lgkmcnt(0)
    v_add_f32 v44, v44, v76
    v_add_f32 v45, v45, v77
    v_add_f32 v46, v46, v78
    v_add_f32 v47, v47, v79
    v_cvt_pk_bf16_f32 v96, v32, v33
    v_cvt_pk_bf16_f32 v97, v34, v35
    v_cvt_pk_bf16_f32 v98, v36, v37
    v_cvt_pk_bf16_f32 v99, v38, v39
    v_cvt_pk_bf16_f32 v100, v40, v41
    v_cvt_pk_bf16_f32 v101, v42, v43
    v_cvt_pk_bf16_f32 v102, v44, v45
    v_cvt_pk_bf16_f32 v103, v46, v47
    s_nop 1
    v_permlane32_swap_b32 v96, v98
    v_permlane32_swap_b32 v97, v99
    v_permlane32_swap_b32 v100, v102
    v_permlane32_swap_b32 v101, v103
    s_nop 1
    ds_write_b128 v26, v[96:99]
    ds_write_b128 v27, v[100:103]
    ds_read_b128 v[104:107], v25
    ds_read_b128 v[108:111], v25 offset:1024
    s_waitcnt lgkmcnt(1)
    buffer_store_dwordx4 v[104:107], v24, s[20:23], s30 offen sc0 sc1
    s_waitcnt lgkmcnt(0)
    buffer_store_dwordx4 v[108:111], v24, s[20:23], s31 offen sc0 sc1
    s_endpgm
standalone__mha_block__prompt_kernel_wosw:
    v_mov_b32 v244, v7
    v_add_u32 v245, 15360, v7
    v_add_u32 v246, 30720, v7
    v_add_u32 v247, 46080, v7
    s_mov_b32 s12, s20
    s_mov_b32 s13, s21
    s_mov_b32 s14, s22
    s_mov_b32 s15, s23
    s_lshl_b32 s56, s57, 4
    s_lshl_b32 s61, s1, 7
    s_add_u32 s56, s56, s61
    s_mov_b32 s54, 0x80000
    s_mov_b32 s55, -1
    s_branch standalone__mha_block__prompt_kernel_loop
standalone__mha_block__prompt_kernel_pwp:
    ds_read_b32 v212, v211
    s_waitcnt lgkmcnt(0)
    v_readfirstlane_b32 s63, v212
    s_nop 0
    s_cmp_ge_u32 s63, s58
    s_cbranch_scc0 standalone__mha_block__prompt_kernel_pwp
    s_branch standalone__mha_block__prompt_kernel_pwr
standalone__mha_block__prompt_kernel_g2:
    s_cmp_eq_u32 s58, 1
    s_cbranch_scc0 standalone__mha_block__prompt_kernel_g2c
    s_mov_b64 exec, 0xff
    global_load_dwordx2 v[4:5], v8, s[46:47] sc1
    s_mov_b64 exec, 0xffffffff
    s_mov_b64 exec, -1
    s_branch standalone__mha_block__prompt_kernel_g2r
standalone__mha_block__prompt_kernel_g2c:
    s_cmp_eq_u32 s58, 7
    s_cbranch_scc1 standalone__mha_block__prompt_kernel_last
    s_mov_b32 s63, 0
    s_mov_b64 exec, 0xff
    s_waitcnt vmcnt(0)
standalone__mha_block__prompt_kernel_g2l:
    v_cmp_ne_u32 vcc, s50, v4
    v_cmp_ne_u32 s[52:53], s51, v5
    s_add_u32 s63, s63, 1
    s_cmp_ge_u32 s63, 262144
    s_cbranch_scc1 standalone__mha_block__prompt_kernel_g2l_x
    s_nop 2
    s_or_b64 s[52:53], vcc, s[52:53]
    s_cbranch_scc0 standalone__mha_block__prompt_kernel_g2l_x
    global_load_dwordx2 v[4:5], v8, s[46:47] sc1
    s_waitcnt vmcnt(0)
    s_branch standalone__mha_block__prompt_kernel_g2l
standalone__mha_block__prompt_kernel_g2l_x:
    s_mov_b64 exec, -1
    s_branch standalone__mha_block__prompt_kernel_g2r
standalone__mha_block__prompt_kernel_slowb:
    v_mov_b32 v16, v24
    v_mov_b32 v17, v25
    v_mov_b32 v18, v26
    v_mov_b32 v19, v27
    v_mov_b32 v20, v28
    v_mov_b32 v21, v29
    v_mov_b32 v22, v30
    v_mov_b32 v23, v31
standalone__mha_block__prompt_kernel_slow:
    s_lshl_b32 s40, s33, 18
    s_add_u32 s40, s40, 4194304
    s_add_u32 s12, s46, s40
    s_addc_u32 s13, s47, 0
    s_mov_b32 s14, 262144
    s_mov_b32 s15, 0x20000
    v_mov_b32 v3, 0xff61b1e6
    s_mov_b32 s40, 0
standalone__mha_block__prompt_kernel_sl1:
    buffer_load_dwordx4 v[160:163], v12, s[12:15], s40 offen
    buffer_load_dwordx4 v[164:167], v12, s[12:15], s40 offen offset:1024
    s_waitcnt vmcnt(0)
    v_mfma_f32_32x32x16_bf16 v[64:79], v[160:163], v[16:19], 0
    v_mfma_f32_32x32x16_bf16 v[64:79], v[164:167], v[20:23], v[64:79]
    s_nop 15
    v_max3_f32 v3, v3, v64, v65
    v_max3_f32 v3, v3, v66, v67
    v_max3_f32 v3, v3, v68, v69
    v_max3_f32 v3, v3, v70, v71
    v_max3_f32 v3, v3, v72, v73
    v_max3_f32 v3, v3, v74, v75
    v_max3_f32 v3, v3, v76, v77
    v_max3_f32 v3, v3, v78, v79
    s_add_u32 s40, s40, 4096
    s_cmp_lt_u32 s40, 262144
    s_cbranch_scc1 standalone__mha_block__prompt_kernel_sl1
    v_mov_b32 v4, v3
    s_nop 1
    v_permlane32_swap_b32 v3, v4
    s_nop 1
    v_max_f32 v3, v3, v4
    v_sub_f32 v32, 0, v3
    v_mov_b32 v96, 0
    v_sub_f32 v33, 0, v3
    v_mov_b32 v97, 0
    v_sub_f32 v34, 0, v3
    v_mov_b32 v98, 0
    v_sub_f32 v35, 0, v3
    v_mov_b32 v99, 0
    v_sub_f32 v36, 0, v3
    v_mov_b32 v100, 0
    v_sub_f32 v37, 0, v3
    v_mov_b32 v101, 0
    v_sub_f32 v38, 0, v3
    v_mov_b32 v102, 0
    v_sub_f32 v39, 0, v3
    v_mov_b32 v103, 0
    v_sub_f32 v40, 0, v3
    v_mov_b32 v104, 0
    v_sub_f32 v41, 0, v3
    v_mov_b32 v105, 0
    v_sub_f32 v42, 0, v3
    v_mov_b32 v106, 0
    v_sub_f32 v43, 0, v3
    v_mov_b32 v107, 0
    v_sub_f32 v44, 0, v3
    v_mov_b32 v108, 0
    v_sub_f32 v45, 0, v3
    v_mov_b32 v109, 0
    v_sub_f32 v46, 0, v3
    v_mov_b32 v110, 0
    v_sub_f32 v47, 0, v3
    v_mov_b32 v111, 0
    v_mov_b32 v144, 0
    v_mov_b32 v145, 0
    v_mov_b32 v146, 0
    v_mov_b32 v147, 0
    s_mov_b32 s40, 0
standalone__mha_block__prompt_kernel_sl2:
    buffer_load_dwordx4 v[160:163], v12, s[12:15], s40 offen
    buffer_load_dwordx4 v[164:167], v12, s[12:15], s40 offen offset:1024
    buffer_load_dwordx4 v[176:179], v12, s[12:15], s40 offen offset:2048
    buffer_load_dwordx4 v[180:183], v12, s[12:15], s40 offen offset:3072
    s_waitcnt vmcnt(0)
    v_mfma_f32_32x32x16_bf16 v[64:79], v[160:163], v[16:19], v[32:47]
    v_mfma_f32_32x32x16_bf16 v[64:79], v[164:167], v[20:23], v[64:79]
    s_nop 15
    v_exp_f32 v64, v64
    v_exp_f32 v65, v65
    v_exp_f32 v66, v66
    v_exp_f32 v67, v67
    v_exp_f32 v68, v68
    v_exp_f32 v69, v69
    v_exp_f32 v70, v70
    v_exp_f32 v71, v71
    v_exp_f32 v72, v72
    v_exp_f32 v73, v73
    v_exp_f32 v74, v74
    v_exp_f32 v75, v75
    v_exp_f32 v76, v76
    v_exp_f32 v77, v77
    v_exp_f32 v78, v78
    v_exp_f32 v79, v79
    s_nop 1
    v_smfmac_f32_32x32x32_bf16 v[96:111], v[176:179], v[64:71], v156
    v_smfmac_f32_32x32x32_bf16 v[96:111], v[180:183], v[72:79], v156
    v_smfmac_f32_16x16x64_bf16 v[144:147], v[152:155], v[64:71], v156
    v_smfmac_f32_16x16x64_bf16 v[144:147], v[152:155], v[72:79], v156
    s_add_u32 s40, s40, 4096
    s_cmp_lt_u32 s40, 262144
    s_cbranch_scc1 standalone__mha_block__prompt_kernel_sl2
    s_nop 15
    s_branch standalone__mha_block__prompt_kernel_fin
standalone__mha_block__prompt_kernel_end:
    s_endpgm
standalone__mha_block__prompt_kernel_codeend:
.section .rodata,"a"
.p2align 6
.amdhsa_kernel standalone__mha_block__prompt_kernel
  .amdhsa_next_free_vgpr 248
  .amdhsa_next_free_sgpr 100
  .amdhsa_accum_offset 248
  .amdhsa_group_segment_fixed_size 0
  .amdhsa_kernarg_size 48
  .amdhsa_user_sgpr_count 2
  .amdhsa_user_sgpr_kernarg_segment_ptr 1
  .amdhsa_system_sgpr_workgroup_id_x 1
.end_amdhsa_kernel
```
